```python
import torch

def _softmax(x, axis=-1):
    return torch.softmax(x, dim=axis)
def _gelu(x):
    return torch.nn.functional.gelu(x, approximate="tanh")
def _silu(x):
    return torch.nn.functional.silu(x)
def _sigmoid(x):
    return torch.sigmoid(x)
def _layernorm(x, axis=-1, eps=1e-5):
    m = x.mean(dim=axis, keepdim=True)
    v = x.var(dim=axis, keepdim=True, unbiased=False)
    return (x - m) / torch.sqrt(v + eps)
def _scatter_add(tgt, idx, src, axis=0):
    return tgt.clone().index_add_(axis, idx, src)
def _segment_sum(src, seg, n):
    out = torch.zeros((n,) + src.shape[1:], dtype=src.dtype)
    return out.index_add_(0, seg, src)
def _pad(x, pw):
    flat = tuple(v for pair in reversed(pw) for v in pair)
    return torch.nn.functional.pad(x, flat)

kernel_name = 'parallel_sum__gqa_block_cached__glu_gated_glu__decode'

def setup_inputs():

    _w = (lambda a: (lambda t: t.to(torch.bfloat16) if t.is_floating_point() else t)(torch.as_tensor(a)))
    def _A_setup():
        B, Sq, D = 1, 1, 576
        Hq, Hkv, Sk, Dh = 32, 16, 65536, 128
        assert Hq % Hkv == 0, (Hq, Hkv)
        return {
            "x": _w((lambda *s: torch.randn(*s, dtype=torch.bfloat16) * 0.05)(B, Sq, D)),
            "k_cache": _w((lambda *s: torch.randn(*s, dtype=torch.bfloat16) * 3.2)(B, Hkv, Sk, Dh)),
            "v_cache": _w((lambda *s: torch.randn(*s, dtype=torch.bfloat16) * 1.6)(B, Hkv, Sk, Dh)),
            "wq": _w((lambda *s: torch.randn(*s, dtype=torch.bfloat16) * 3.2)(D, Hq * Dh) * (D ** -0.5)),
            "wo": _w((lambda *s: torch.randn(*s, dtype=torch.bfloat16) * 1.6)(Hq * Dh, D) * ((Hq * Dh) ** -0.5)),
        }
    _A_in = _A_setup()

    def _B_setup():
        B, S, D, F = 1, 1, 576, 4608
        return {
            "x": _w((lambda *s: torch.randn(*s, dtype=torch.bfloat16) * 0.05)(B, S, D)),
            "w_gate": _w((lambda *s: torch.randn(*s, dtype=torch.bfloat16) * 0.1)(D, F)),
            "w_up": _w((lambda *s: torch.randn(*s, dtype=torch.bfloat16) * 0.05)(D, F)),
            "w_down": _w((lambda *s: torch.randn(*s, dtype=torch.bfloat16) * 0.05)(F, D)),
        }
    _B_in = _B_setup()

    return {
        "A_x": _A_in["x"],
        "A_k_cache": _A_in["k_cache"],
        "A_v_cache": _A_in["v_cache"],
        "A_wq": _A_in["wq"],
        "A_wo": _A_in["wo"],
        "B_x": _B_in["x"],
        "B_w_gate": _B_in["w_gate"],
        "B_w_up": _B_in["w_up"],
        "B_w_down": _B_in["w_down"],
    }

def reference(A_x, A_k_cache, A_v_cache, A_wq, A_wo, B_x, B_w_gate, B_w_up, B_w_down):
    def _A_ref(x, k_cache, v_cache, wq, wo):
        B, Sq, D = x.shape
        Hq, Dh = 32, 128
        Hkv = k_cache.shape[1]
        rep = Hq // Hkv
        q = (lambda x, *d: x.permute(*d))((x @ wq).reshape(B, Sq, Hq, Dh), 0, 2, 1, 3)
        k = (lambda x, n, axis: torch.repeat_interleave(x, n, dim=axis))(k_cache, rep, axis=1)
        v = (lambda x, n, axis: torch.repeat_interleave(x, n, dim=axis))(v_cache, rep, axis=1)
        scores = torch.einsum("bhqd,bhkd->bhqk", q, k) * (Dh ** -0.5)
        p = _softmax(scores, axis=-1)
        o = torch.einsum("bhqk,bhkd->bhqd", p, v)
        return (lambda x, *d: x.permute(*d))(o, 0, 2, 1, 3).reshape(B, Sq, Hq * Dh) @ wo

    def _B_ref(x, w_gate, w_up, w_down):
        g = torch.einsum("bsd,df->bsf", x, w_gate)
        u = torch.einsum("bsd,df->bsf", x, w_up)
        h = _sigmoid(g) * u
        return torch.einsum("bsf,fd->bsd", h, w_down)

    x = A_x
    xn = _layernorm(x, axis=-1)
    return x + _A_ref(xn, A_k_cache, A_v_cache, A_wq, A_wo) + _B_ref(xn, B_w_gate, B_w_up, B_w_down)
```

```asm
; @launch grid=(256,1,1) block=(320,1,1) lds=4096
.amdgcn_target "amdgcn-amd-amdhsa--gfx950"
.text
.globl parallel_sum__gqa_block_cached__glu_gated_glu__decode_kernel
.p2align 8
.type parallel_sum__gqa_block_cached__glu_gated_glu__decode_kernel,@function
parallel_sum__gqa_block_cached__glu_gated_glu__decode_kernel:
    s_cmp_ge_u32 s2, 256
    s_cbranch_scc1 L_end
    s_load_dwordx16 s[4:19], s[0:1], 0
    s_load_dwordx8 s[20:27], s[0:1], 64
    v_lshrrev_b32 v2, 6, v0
    v_and_b32 v1, 63, v0
    v_readfirstlane_b32 s3, v2
    s_lshr_b32 s28, s2, 4
    s_and_b32 s29, s2, 15
    v_lshlrev_b32 v3, 4, v1
    s_cmp_ge_u32 s3, 3
    s_cbranch_scc1 L_stream
    s_cmp_eq_u32 s3, 1
    s_cbranch_scc1 L_waveB
    s_cmp_eq_u32 s3, 2
    s_cbranch_scc1 L_waveT
    s_setprio 3
    v_lshrrev_b32 v10, 3, v1
    v_lshlrev_b32 v2, 13, v10
    v_and_b32 v11, 7, v1
    v_lshl_add_u32 v2, v11, 4, v2
    s_lshr_b32 s30, s29, 2
    s_and_b32 s31, s29, 3
    s_mul_i32 s52, s30, 1179648
    s_lshl_b32 s53, s28, 9
    s_add_u32 s52, s52, s53
    s_lshl_b32 s53, s31, 7
    s_add_u32 s52, s52, s53
    s_mov_b32 s54, 65536
    v_mov_b32 v56, 0
    v_mov_b32 v57, 0
    ds_write_b64 v57, v[56:57] offset:3072
    s_waitcnt lgkmcnt(0)
    s_load_dword s77, s[26:27], 32768
    s_mov_b32 s96, 255
    s_not_b32 s97, s96
    s_mov_b32 s32, s4
    s_mov_b32 s33, s5
    s_mov_b32 s34, 1152
    s_mov_b32 s35, 0x20000
    s_mov_b32 s36, s10
    s_mov_b32 s37, s11
    s_mov_b32 s38, 4718592
    s_mov_b32 s39, 0x20000
    s_mov_b32 s40, s26
    s_mov_b32 s41, s27
    s_mov_b32 s42, 2097152
    s_mov_b32 s43, 0x20000
    s_cmp_lg_u32 s29, 0
    s_cbranch_scc1 L_noctr
    s_lshl_b32 s53, s28, 10
    v_lshlrev_b32 v4, 8, v1
    s_mov_b64 exec, 1
    buffer_store_dword v57, v4, s[40:43], s53 offen sc1
    s_mov_b64 exec, -1
L_noctr:
    buffer_load_dwordx4 v[48:51], v3, s[32:35], 0 offen
    buffer_load_dwordx4 v[52:55], v3, s[32:35], 0 offen offset:1024
    buffer_load_dwordx4 v[64:67], v2, s[36:39], s52 offen nt
    s_add_u32 s52, s52, s54
    buffer_load_dwordx4 v[68:71], v2, s[36:39], s52 offen nt
    s_add_u32 s52, s52, s54
    buffer_load_dwordx4 v[72:75], v2, s[36:39], s52 offen nt
    s_add_u32 s52, s52, s54
    buffer_load_dwordx4 v[76:79], v2, s[36:39], s52 offen nt
    s_add_u32 s52, s52, s54
    buffer_load_dwordx4 v[80:83], v2, s[36:39], s52 offen nt
    s_add_u32 s52, s52, s54
    buffer_load_dwordx4 v[84:87], v2, s[36:39], s52 offen nt
    s_add_u32 s52, s52, s54
    buffer_load_dwordx4 v[88:91], v2, s[36:39], s52 offen nt
    s_add_u32 s52, s52, s54
    buffer_load_dwordx4 v[92:95], v2, s[36:39], s52 offen nt
    s_add_u32 s52, s52, s54
    buffer_load_dwordx4 v[96:99], v2, s[36:39], s52 offen nt
    s_add_u32 s52, s52, s54
    buffer_load_dwordx4 v[100:103], v2, s[36:39], s52 offen nt
    s_add_u32 s52, s52, s54
    buffer_load_dwordx4 v[104:107], v2, s[36:39], s52 offen nt
    s_add_u32 s52, s52, s54
    buffer_load_dwordx4 v[108:111], v2, s[36:39], s52 offen nt
    s_add_u32 s52, s52, s54
    buffer_load_dwordx4 v[112:115], v2, s[36:39], s52 offen nt
    s_add_u32 s52, s52, s54
    buffer_load_dwordx4 v[116:119], v2, s[36:39], s52 offen nt
    s_add_u32 s52, s52, s54
    buffer_load_dwordx4 v[120:123], v2, s[36:39], s52 offen nt
    s_add_u32 s52, s52, s54
    buffer_load_dwordx4 v[124:127], v2, s[36:39], s52 offen nt
    s_add_u32 s52, s52, s54
    buffer_load_dwordx4 v[128:131], v2, s[36:39], s52 offen nt
    s_add_u32 s52, s52, s54
    buffer_load_dwordx4 v[132:135], v2, s[36:39], s52 offen nt
    s_barrier
    v_and_b32 v10, 1, v1
    v_lshlrev_b32 v10, 4, v10
    v_mov_b32 v11, 0xffff
    v_lshlrev_b32 v11, v10, v11
    v_bfe_u32 v10, v1, 1, 2
    v_cmp_eq_u32 s[90:91], 0, v10
    v_cmp_eq_u32 s[92:93], 1, v10
    v_cmp_eq_u32 s[94:95], 2, v10
    v_cmp_eq_u32 vcc, 3, v10
    v_cndmask_b32 v14, 0, v11, s[90:91]
    v_cndmask_b32 v15, 0, v11, s[92:93]
    v_cndmask_b32 v16, 0, v11, s[94:95]
    v_cndmask_b32 v17, 0, v11, vcc
    s_waitcnt vmcnt(18)
    v_lshlrev_b32 v224, 16, v48
    v_and_b32 v225, 0xffff0000, v48
    v_lshlrev_b32 v226, 16, v49
    v_and_b32 v227, 0xffff0000, v49
    v_lshlrev_b32 v228, 16, v50
    v_and_b32 v229, 0xffff0000, v50
    v_lshlrev_b32 v230, 16, v51
    v_and_b32 v231, 0xffff0000, v51
    v_lshlrev_b32 v232, 16, v52
    v_and_b32 v233, 0xffff0000, v52
    v_lshlrev_b32 v234, 16, v53
    v_and_b32 v235, 0xffff0000, v53
    v_lshlrev_b32 v236, 16, v54
    v_and_b32 v237, 0xffff0000, v54
    v_lshlrev_b32 v238, 16, v55
    v_and_b32 v239, 0xffff0000, v55
    v_pk_add_f32 v[12:13], v[224:225], v[226:227]
    v_pk_add_f32 v[12:13], v[12:13], v[228:229]
    v_pk_add_f32 v[12:13], v[12:13], v[230:231]
    v_pk_add_f32 v[12:13], v[12:13], v[232:233]
    v_pk_add_f32 v[12:13], v[12:13], v[234:235]
    v_pk_add_f32 v[12:13], v[12:13], v[236:237]
    v_pk_add_f32 v[12:13], v[12:13], v[238:239]
    v_add_f32 v10, v12, v13
    s_nop 1
    v_add_f32_dpp v10, v10, v10 row_ror:8 row_mask:0xf bank_mask:0xf
    s_nop 1
    v_add_f32_dpp v10, v10, v10 row_ror:4 row_mask:0xf bank_mask:0xf
    s_nop 1
    v_add_f32_dpp v10, v10, v10 row_ror:2 row_mask:0xf bank_mask:0xf
    s_nop 1
    v_add_f32_dpp v10, v10, v10 row_ror:1 row_mask:0xf bank_mask:0xf
    s_nop 1
    v_add_f32_dpp v10, v10, v10 row_bcast:15 row_mask:0xa bank_mask:0xf
    s_nop 1
    v_add_f32_dpp v10, v10, v10 row_bcast:31 row_mask:0xc bank_mask:0xf
    s_nop 0
    v_readlane_b32 s99, v10, 63
    v_mov_b32 v11, 0x3ae38e39
    s_nop 0
    v_mul_f32 v12, s99, v11
    v_sub_f32 v13, v224, v12
    v_mul_f32 v10, v13, v13
    v_sub_f32 v13, v225, v12
    v_fmac_f32 v10, v13, v13
    v_sub_f32 v13, v226, v12
    v_fmac_f32 v10, v13, v13
    v_sub_f32 v13, v227, v12
    v_fmac_f32 v10, v13, v13
    v_sub_f32 v13, v228, v12
    v_fmac_f32 v10, v13, v13
    v_sub_f32 v13, v229, v12
    v_fmac_f32 v10, v13, v13
    v_sub_f32 v13, v230, v12
    v_fmac_f32 v10, v13, v13
    v_sub_f32 v13, v231, v12
    v_fmac_f32 v10, v13, v13
    v_sub_f32 v13, v232, v12
    v_mul_f32 v18, v13, v13
    v_sub_f32 v13, v233, v12
    v_fmac_f32 v18, v13, v13
    v_sub_f32 v13, v234, v12
    v_fmac_f32 v18, v13, v13
    v_sub_f32 v13, v235, v12
    v_fmac_f32 v18, v13, v13
    v_sub_f32 v13, v236, v12
    v_fmac_f32 v18, v13, v13
    v_sub_f32 v13, v237, v12
    v_fmac_f32 v18, v13, v13
    v_sub_f32 v13, v238, v12
    v_fmac_f32 v18, v13, v13
    v_sub_f32 v13, v239, v12
    v_fmac_f32 v18, v13, v13
    v_cmp_gt_u32 vcc, 8, v1
    s_nop 1
    v_cndmask_b32 v18, 0, v18, vcc
    v_add_f32 v10, v10, v18
    s_nop 1
    v_add_f32_dpp v10, v10, v10 row_ror:8 row_mask:0xf bank_mask:0xf
    s_nop 1
    v_add_f32_dpp v10, v10, v10 row_ror:4 row_mask:0xf bank_mask:0xf
    s_nop 1
    v_add_f32_dpp v10, v10, v10 row_ror:2 row_mask:0xf bank_mask:0xf
    s_nop 1
    v_add_f32_dpp v10, v10, v10 row_ror:1 row_mask:0xf bank_mask:0xf
    s_nop 1
    v_add_f32_dpp v10, v10, v10 row_bcast:15 row_mask:0xa bank_mask:0xf
    s_nop 1
    v_add_f32_dpp v10, v10, v10 row_bcast:31 row_mask:0xc bank_mask:0xf
    s_nop 0
    v_readlane_b32 s99, v10, 63
    s_nop 1
    v_mul_f32 v13, s99, v11
    v_cvt_pk_bf16_f32 v12, v12, v12
    v_and_b32 v12, 0xffff0000, v12
    v_cvt_pk_bf16_f32 v13, v13, v13
    v_and_b32 v13, 0xffff0000, v13
    v_add_f32 v13, 0x3727c5ac, v13
    v_cvt_pk_bf16_f32 v13, v13, v13
    v_and_b32 v13, 0xffff0000, v13
    v_sqrt_f32 v13, v13
    s_nop 0
    v_cvt_pk_bf16_f32 v13, v13, v13
    v_and_b32 v13, 0xffff0000, v13
    v_rcp_f32 v18, v13
    v_lshlrev_b32 v9, 2, v1
    v_sub_f32 v224, v224, v12
    v_sub_f32 v225, v225, v12
    v_cvt_pk_bf16_f32 v10, v224, v225
    v_lshlrev_b32 v224, 16, v10
    v_and_b32 v225, 0xffff0000, v10
    v_mul_f32 v10, v224, v18
    v_fma_f32 v11, -v10, v13, v224
    v_fma_f32 v10, v11, v18, v10
    v_cvt_pk_bf16_f32 v224, v10, v10
    ds_write_b32 v9, v224 offset:0
    v_mul_f32 v10, v225, v18
    v_fma_f32 v11, -v10, v13, v225
    v_fma_f32 v10, v11, v18, v10
    v_cvt_pk_bf16_f32 v225, v10, v10
    ds_write_b32 v9, v225 offset:288
    v_sub_f32 v226, v226, v12
    v_sub_f32 v227, v227, v12
    v_cvt_pk_bf16_f32 v10, v226, v227
    v_lshlrev_b32 v226, 16, v10
    v_and_b32 v227, 0xffff0000, v10
    v_mul_f32 v10, v226, v18
    v_fma_f32 v11, -v10, v13, v226
    v_fma_f32 v10, v11, v18, v10
    v_cvt_pk_bf16_f32 v226, v10, v10
    ds_write_b32 v9, v226 offset:576
    v_mul_f32 v10, v227, v18
    v_fma_f32 v11, -v10, v13, v227
    v_fma_f32 v10, v11, v18, v10
    v_cvt_pk_bf16_f32 v227, v10, v10
    ds_write_b32 v9, v227 offset:864
    v_sub_f32 v228, v228, v12
    v_sub_f32 v229, v229, v12
    v_cvt_pk_bf16_f32 v10, v228, v229
    v_lshlrev_b32 v228, 16, v10
    v_and_b32 v229, 0xffff0000, v10
    v_mul_f32 v10, v228, v18
    v_fma_f32 v11, -v10, v13, v228
    v_fma_f32 v10, v11, v18, v10
    v_cvt_pk_bf16_f32 v228, v10, v10
    ds_write_b32 v9, v228 offset:1152
    v_mul_f32 v10, v229, v18
    v_fma_f32 v11, -v10, v13, v229
    v_fma_f32 v10, v11, v18, v10
    v_cvt_pk_bf16_f32 v229, v10, v10
    ds_write_b32 v9, v229 offset:1440
    v_sub_f32 v230, v230, v12
    v_sub_f32 v231, v231, v12
    v_cvt_pk_bf16_f32 v10, v230, v231
    v_lshlrev_b32 v230, 16, v10
    v_and_b32 v231, 0xffff0000, v10
    v_mul_f32 v10, v230, v18
    v_fma_f32 v11, -v10, v13, v230
    v_fma_f32 v10, v11, v18, v10
    v_cvt_pk_bf16_f32 v230, v10, v10
    ds_write_b32 v9, v230 offset:1728
    v_mul_f32 v10, v231, v18
    v_fma_f32 v11, -v10, v13, v231
    v_fma_f32 v10, v11, v18, v10
    v_cvt_pk_bf16_f32 v231, v10, v10
    ds_write_b32 v9, v231 offset:2016
    s_mov_b64 exec, 0xff
    v_sub_f32 v232, v232, v12
    v_sub_f32 v233, v233, v12
    v_cvt_pk_bf16_f32 v10, v232, v233
    v_lshlrev_b32 v232, 16, v10
    v_and_b32 v233, 0xffff0000, v10
    v_mul_f32 v10, v232, v18
    v_fma_f32 v11, -v10, v13, v232
    v_fma_f32 v10, v11, v18, v10
    v_cvt_pk_bf16_f32 v232, v10, v10
    ds_write_b32 v9, v232 offset:256
    v_mul_f32 v10, v233, v18
    v_fma_f32 v11, -v10, v13, v233
    v_fma_f32 v10, v11, v18, v10
    v_cvt_pk_bf16_f32 v233, v10, v10
    ds_write_b32 v9, v233 offset:544
    v_sub_f32 v234, v234, v12
    v_sub_f32 v235, v235, v12
    v_cvt_pk_bf16_f32 v10, v234, v235
    v_lshlrev_b32 v234, 16, v10
    v_and_b32 v235, 0xffff0000, v10
    v_mul_f32 v10, v234, v18
    v_fma_f32 v11, -v10, v13, v234
    v_fma_f32 v10, v11, v18, v10
    v_cvt_pk_bf16_f32 v234, v10, v10
    ds_write_b32 v9, v234 offset:832
    v_mul_f32 v10, v235, v18
    v_fma_f32 v11, -v10, v13, v235
    v_fma_f32 v10, v11, v18, v10
    v_cvt_pk_bf16_f32 v235, v10, v10
    ds_write_b32 v9, v235 offset:1120
    v_sub_f32 v236, v236, v12
    v_sub_f32 v237, v237, v12
    v_cvt_pk_bf16_f32 v10, v236, v237
    v_lshlrev_b32 v236, 16, v10
    v_and_b32 v237, 0xffff0000, v10
    v_mul_f32 v10, v236, v18
    v_fma_f32 v11, -v10, v13, v236
    v_fma_f32 v10, v11, v18, v10
    v_cvt_pk_bf16_f32 v236, v10, v10
    ds_write_b32 v9, v236 offset:1408
    v_mul_f32 v10, v237, v18
    v_fma_f32 v11, -v10, v13, v237
    v_fma_f32 v10, v11, v18, v10
    v_cvt_pk_bf16_f32 v237, v10, v10
    ds_write_b32 v9, v237 offset:1696
    v_sub_f32 v238, v238, v12
    v_sub_f32 v239, v239, v12
    v_cvt_pk_bf16_f32 v10, v238, v239
    v_lshlrev_b32 v238, 16, v10
    v_and_b32 v239, 0xffff0000, v10
    v_mul_f32 v10, v238, v18
    v_fma_f32 v11, -v10, v13, v238
    v_fma_f32 v10, v11, v18, v10
    v_cvt_pk_bf16_f32 v238, v10, v10
    ds_write_b32 v9, v238 offset:1984
    v_mul_f32 v10, v239, v18
    v_fma_f32 v11, -v10, v13, v239
    v_fma_f32 v10, v11, v18, v10
    v_cvt_pk_bf16_f32 v239, v10, v10
    ds_write_b32 v9, v239 offset:2272
    s_mov_b64 exec, -1
    v_lshrrev_b32 v10, 3, v1
    v_mul_u32_u24 v10, 288, v10
    s_mul_i32 s52, s30, 72
    v_add_u32 v10, s52, v10
    v_mov_b32 v11, 1
    s_waitcnt lgkmcnt(0)
    ds_write_b32 v57, v11 offset:3072
    ds_read_b64 v[216:217], v10 offset:0
    ds_read_b64 v[218:219], v10 offset:8
    ds_read_b64 v[220:221], v10 offset:16
    ds_read_b64 v[222:223], v10 offset:24
    ds_read_b64 v[224:225], v10 offset:32
    ds_read_b64 v[226:227], v10 offset:40
    ds_read_b64 v[228:229], v10 offset:48
    ds_read_b64 v[230:231], v10 offset:56
    ds_read_b64 v[232:233], v10 offset:64
    s_add_u32 s77, s77, 1
    s_and_b32 s76, s77, s96
    v_mov_b32 v19, s76
    v_bfe_u32 v10, v1, 4, 1
    v_and_b32 v11, 7, v1
    v_lshl_add_u32 v10, v10, 3, v11
    v_lshlrev_b32 v13, 4, v10
    s_lshl_b32 s52, s2, 8
    s_add_u32 s52, s52, 65536
    s_lshl_b32 s53, s28, 12
    s_add_u32 s53, s53, 65536
    s_add_u32 s55, s53, 4096
    s_waitcnt vmcnt(0) lgkmcnt(0)
    v_and_b32 v32, v216, v14
    v_and_b32 v33, v216, v15
    v_and_b32 v34, v216, v16
    v_and_b32 v35, v216, v17
    v_and_b32 v36, v217, v14
    v_and_b32 v37, v217, v15
    v_and_b32 v38, v217, v16
    v_and_b32 v39, v217, v17
    v_mfma_f32_16x16x32_bf16 v[20:23], v[64:67], v[32:35], 0
    v_and_b32 v40, v218, v14
    v_and_b32 v41, v218, v15
    v_and_b32 v42, v218, v16
    v_and_b32 v43, v218, v17
    v_mfma_f32_16x16x32_bf16 v[20:23], v[68:71], v[36:39], v[20:23]
    v_and_b32 v44, v219, v14
    v_and_b32 v45, v219, v15
    v_and_b32 v46, v219, v16
    v_and_b32 v47, v219, v17
    v_mfma_f32_16x16x32_bf16 v[20:23], v[72:75], v[40:43], v[20:23]
    v_and_b32 v32, v220, v14
    v_and_b32 v33, v220, v15
    v_and_b32 v34, v220, v16
    v_and_b32 v35, v220, v17
    v_mfma_f32_16x16x32_bf16 v[20:23], v[76:79], v[44:47], v[20:23]
    v_and_b32 v36, v221, v14
    v_and_b32 v37, v221, v15
    v_and_b32 v38, v221, v16
    v_and_b32 v39, v221, v17
    v_mfma_f32_16x16x32_bf16 v[20:23], v[80:83], v[32:35], v[20:23]
    v_and_b32 v40, v222, v14
    v_and_b32 v41, v222, v15
    v_and_b32 v42, v222, v16
    v_and_b32 v43, v222, v17
    v_mfma_f32_16x16x32_bf16 v[20:23], v[84:87], v[36:39], v[20:23]
    v_and_b32 v44, v223, v14
    v_and_b32 v45, v223, v15
    v_and_b32 v46, v223, v16
    v_and_b32 v47, v223, v17
    v_mfma_f32_16x16x32_bf16 v[20:23], v[88:91], v[40:43], v[20:23]
    v_and_b32 v32, v224, v14
    v_and_b32 v33, v224, v15
    v_and_b32 v34, v224, v16
    v_and_b32 v35, v224, v17
    v_mfma_f32_16x16x32_bf16 v[20:23], v[92:95], v[44:47], v[20:23]
    v_and_b32 v36, v225, v14
    v_and_b32 v37, v225, v15
    v_and_b32 v38, v225, v16
    v_and_b32 v39, v225, v17
    v_mfma_f32_16x16x32_bf16 v[20:23], v[96:99], v[32:35], v[20:23]
    v_and_b32 v40, v226, v14
    v_and_b32 v41, v226, v15
    v_and_b32 v42, v226, v16
    v_and_b32 v43, v226, v17
    v_mfma_f32_16x16x32_bf16 v[20:23], v[100:103], v[36:39], v[20:23]
    v_and_b32 v44, v227, v14
    v_and_b32 v45, v227, v15
    v_and_b32 v46, v227, v16
    v_and_b32 v47, v227, v17
    v_mfma_f32_16x16x32_bf16 v[20:23], v[104:107], v[40:43], v[20:23]
    v_and_b32 v32, v228, v14
    v_and_b32 v33, v228, v15
    v_and_b32 v34, v228, v16
    v_and_b32 v35, v228, v17
    v_mfma_f32_16x16x32_bf16 v[20:23], v[108:111], v[44:47], v[20:23]
    v_and_b32 v36, v229, v14
    v_and_b32 v37, v229, v15
    v_and_b32 v38, v229, v16
    v_and_b32 v39, v229, v17
    v_mfma_f32_16x16x32_bf16 v[20:23], v[112:115], v[32:35], v[20:23]
    v_and_b32 v40, v230, v14
    v_and_b32 v41, v230, v15
    v_and_b32 v42, v230, v16
    v_and_b32 v43, v230, v17
    v_mfma_f32_16x16x32_bf16 v[20:23], v[116:119], v[36:39], v[20:23]
    v_and_b32 v44, v231, v14
    v_and_b32 v45, v231, v15
    v_and_b32 v46, v231, v16
    v_and_b32 v47, v231, v17
    v_mfma_f32_16x16x32_bf16 v[20:23], v[120:123], v[40:43], v[20:23]
    v_and_b32 v32, v232, v14
    v_and_b32 v33, v232, v15
    v_and_b32 v34, v232, v16
    v_and_b32 v35, v232, v17
    v_mfma_f32_16x16x32_bf16 v[20:23], v[124:127], v[44:47], v[20:23]
    v_and_b32 v36, v233, v14
    v_and_b32 v37, v233, v15
    v_and_b32 v38, v233, v16
    v_and_b32 v39, v233, v17
    v_mfma_f32_16x16x32_bf16 v[20:23], v[128:131], v[32:35], v[20:23]
    s_nop 0
    v_mfma_f32_16x16x32_bf16 v[20:23], v[132:135], v[36:39], v[20:23]
    s_nop 7
    v_mov_b32_dpp v20, v20 row_ror:8 row_mask:0xc bank_mask:0xf
    v_mov_b32_dpp v21, v21 row_ror:8 row_mask:0xc bank_mask:0xf
    v_mov_b32_dpp v22, v22 row_ror:8 row_mask:0xc bank_mask:0xf
    v_mov_b32_dpp v23, v23 row_ror:8 row_mask:0xc bank_mask:0xf
    v_mov_b32 v24, v20
    v_mov_b32 v25, v21
    v_mov_b32 v26, v22
    v_mov_b32 v27, v23
    v_permlane32_swap_b32 v24, v20
    v_permlane32_swap_b32 v25, v21
    v_permlane32_swap_b32 v26, v22
    v_permlane32_swap_b32 v27, v23
    v_add_f32 v20, v20, v24
    v_add_f32 v21, v21, v25
    v_add_f32 v22, v22, v26
    v_add_f32 v23, v23, v27
    v_and_or_b32 v20, v20, s97, v19
    v_and_or_b32 v21, v21, s97, v19
    v_and_or_b32 v22, v22, s97, v19
    v_and_or_b32 v23, v23, s97, v19
    s_mov_b32 exec_lo, 0x00ff00ff
    s_mov_b32 exec_hi, 0
    buffer_store_dwordx4 v[20:23], v13, s[40:43], s52 offen sc1
    s_mov_b64 exec, -1
    v_lshrrev_b32 v13, 3, v1
    v_lshlrev_b32 v13, 5, v13
    v_and_b32 v11, 7, v1
    v_add_lshl_u32 v13, v13, v11, 1
    s_mov_b32 s76, 400000
L_poll1:
    buffer_load_dwordx4 v[80:83], v3, s[40:43], s53 offen offset:0 sc1
    buffer_load_dwordx4 v[84:87], v3, s[40:43], s53 offen offset:1024 sc1
    buffer_load_dwordx4 v[88:91], v3, s[40:43], s53 offen offset:2048 sc1
    buffer_load_dwordx4 v[92:95], v3, s[40:43], s53 offen offset:3072 sc1
L_poll1_w:
    s_waitcnt vmcnt(0)
L_poll1_c:
    v_xor_b32 v64, v80, v19
    v_xor_b32 v65, v81, v19
    v_xor_b32 v66, v82, v19
    v_xor_b32 v67, v83, v19
    v_xor_b32 v68, v84, v19
    v_xor_b32 v69, v85, v19
    v_xor_b32 v70, v86, v19
    v_xor_b32 v71, v87, v19
    v_xor_b32 v72, v88, v19
    v_xor_b32 v73, v89, v19
    v_xor_b32 v74, v90, v19
    v_xor_b32 v75, v91, v19
    v_xor_b32 v76, v92, v19
    v_xor_b32 v77, v93, v19
    v_xor_b32 v78, v94, v19
    v_xor_b32 v79, v95, v19
    v_or3_b32 v10, v64, v65, v66
    v_or3_b32 v11, v67, v68, v69
    v_or3_b32 v10, v10, v70, v71
    v_or3_b32 v11, v11, v72, v73
    v_or3_b32 v10, v10, v74, v75
    v_or3_b32 v11, v11, v76, v77
    v_or3_b32 v10, v10, v78, v79
    v_or_b32 v10, v10, v11
    v_and_b32 v10, s96, v10
    v_cmp_ne_u32 vcc, 0, v10
    s_cbranch_vccz L_polld2
    s_sub_u32 s76, s76, 1
    s_cbranch_scc1 L_polld2
    s_sleep 1
    s_branch L_poll1
L_polld2:
    v_pk_add_f32 v[20:21], v[64:65], v[72:73]
    v_pk_add_f32 v[22:23], v[66:67], v[74:75]
    v_pk_add_f32 v[24:25], v[68:69], v[76:77]
    v_pk_add_f32 v[26:27], v[70:71], v[78:79]
    v_pk_add_f32 v[20:21], v[20:21], v[24:25]
    v_pk_add_f32 v[22:23], v[22:23], v[26:27]
    v_cvt_pk_bf16_f32 v20, v20, v20
    v_cvt_pk_bf16_f32 v21, v21, v21
    v_cvt_pk_bf16_f32 v22, v22, v22
    v_cvt_pk_bf16_f32 v23, v23, v23
    ds_write_b16 v13, v20 offset:2304
    ds_write_b16 v13, v21 offset:2320
    ds_write_b16 v13, v22 offset:2336
    ds_write_b16 v13, v23 offset:2352
    v_mov_b32 v11, 2
    s_waitcnt lgkmcnt(0)
    ds_write_b32 v57, v11 offset:3072
    s_endpgm
L_waveB:
    s_setprio 1
    s_lshr_b32 s30, s28, 1
    s_and_b32 s31, s28, 1
    s_mul_i32 s52, s30, 1152
    s_lshr_b32 s54, s29, 2
    s_mul_i32 s56, s54, 1327104
    s_add_u32 s56, s56, s52
    s_and_b32 s53, s29, 3
    s_lshl_b32 s53, s53, 8
    s_add_u32 s56, s56, s53
    s_mul_i32 s58, s29, 331776
    s_add_u32 s58, s58, s52
    s_mov_b32 s57, 36864
    v_lshrrev_b32 v8, 4, v1
    v_and_b32 v9, 15, v1
    v_mul_u32_u24 v4, 9216, v8
    v_lshl_add_u32 v4, v9, 4, v4
    v_mov_b32 v5, 0x40000000
    v_cmp_gt_u32 vcc, 8, v9
    s_nop 1
    v_cndmask_b32 v5, v5, v4, vcc
    s_cmp_eq_u32 s31, 0
    s_waitcnt lgkmcnt(0)
    s_cselect_b32 s32, s16, s18
    s_cselect_b32 s33, s17, s19
    s_mov_b32 s34, 5308416
    s_mov_b32 s35, 0x20000
    s_barrier
    buffer_load_dwordx4 v[64:67], v4, s[32:35], s56 offen offset:0 nt
    s_add_u32 s56, s56, s57
    buffer_load_dwordx4 v[68:71], v4, s[32:35], s56 offen offset:0 nt
    s_add_u32 s56, s56, s57
    buffer_load_dwordx4 v[72:75], v4, s[32:35], s56 offen offset:0 nt
    s_add_u32 s56, s56, s57
    buffer_load_dwordx4 v[76:79], v4, s[32:35], s56 offen offset:0 nt
    s_add_u32 s56, s56, s57
    buffer_load_dwordx4 v[80:83], v4, s[32:35], s56 offen offset:0 nt
    s_add_u32 s56, s56, s57
    buffer_load_dwordx4 v[84:87], v4, s[32:35], s56 offen offset:0 nt
    s_add_u32 s56, s56, s57
    buffer_load_dwordx4 v[88:91], v4, s[32:35], s56 offen offset:0 nt
    s_add_u32 s56, s56, s57
    buffer_load_dwordx4 v[92:95], v4, s[32:35], s56 offen offset:0 nt
    s_add_u32 s56, s56, s57
    buffer_load_dwordx4 v[96:99], v4, s[32:35], s56 offen offset:0 nt
    s_add_u32 s56, s56, s57
    buffer_load_dwordx4 v[100:103], v4, s[32:35], s56 offen offset:0 nt
    s_add_u32 s56, s56, s57
    buffer_load_dwordx4 v[104:107], v4, s[32:35], s56 offen offset:0 nt
    s_add_u32 s56, s56, s57
    buffer_load_dwordx4 v[108:111], v4, s[32:35], s56 offen offset:0 nt
    s_add_u32 s56, s56, s57
    buffer_load_dwordx4 v[112:115], v4, s[32:35], s56 offen offset:0 nt
    s_add_u32 s56, s56, s57
    buffer_load_dwordx4 v[116:119], v4, s[32:35], s56 offen offset:0 nt
    s_add_u32 s56, s56, s57
    buffer_load_dwordx4 v[120:123], v4, s[32:35], s56 offen offset:0 nt
    s_add_u32 s56, s56, s57
    buffer_load_dwordx4 v[124:127], v4, s[32:35], s56 offen offset:0 nt
    s_add_u32 s56, s56, s57
    buffer_load_dwordx4 v[128:131], v4, s[32:35], s56 offen offset:0 nt
    s_add_u32 s56, s56, s57
    buffer_load_dwordx4 v[132:135], v4, s[32:35], s56 offen offset:0 nt
    s_add_u32 s56, s56, s57
    buffer_load_dwordx4 v[136:139], v4, s[32:35], s56 offen offset:0 nt
    s_add_u32 s56, s56, s57
    buffer_load_dwordx4 v[140:143], v4, s[32:35], s56 offen offset:0 nt
    s_add_u32 s56, s56, s57
    buffer_load_dwordx4 v[144:147], v4, s[32:35], s56 offen offset:0 nt
    s_add_u32 s56, s56, s57
    buffer_load_dwordx4 v[148:151], v4, s[32:35], s56 offen offset:0 nt
    s_add_u32 s56, s56, s57
    buffer_load_dwordx4 v[152:155], v4, s[32:35], s56 offen offset:0 nt
    s_add_u32 s56, s56, s57
    buffer_load_dwordx4 v[156:159], v4, s[32:35], s56 offen offset:0 nt
    s_add_u32 s56, s56, s57
    buffer_load_dwordx4 v[160:163], v4, s[32:35], s56 offen offset:0 nt
    s_add_u32 s56, s56, s57
    buffer_load_dwordx4 v[164:167], v4, s[32:35], s56 offen offset:0 nt
    s_add_u32 s56, s56, s57
    buffer_load_dwordx4 v[168:171], v4, s[32:35], s56 offen offset:0 nt
    s_add_u32 s56, s56, s57
    buffer_load_dwordx4 v[172:175], v4, s[32:35], s56 offen offset:0 nt
    s_add_u32 s56, s56, s57
    buffer_load_dwordx4 v[176:179], v4, s[32:35], s56 offen offset:0 nt
    s_add_u32 s56, s56, s57
    buffer_load_dwordx4 v[180:183], v4, s[32:35], s56 offen offset:0 nt
    s_add_u32 s56, s56, s57
    buffer_load_dwordx4 v[184:187], v4, s[32:35], s56 offen offset:0 nt
    s_add_u32 s56, s56, s57
    buffer_load_dwordx4 v[188:191], v4, s[32:35], s56 offen offset:0 nt
    s_add_u32 s56, s56, s57
    buffer_load_dwordx4 v[192:195], v4, s[32:35], s56 offen offset:0 nt
    s_add_u32 s56, s56, s57
    buffer_load_dwordx4 v[196:199], v4, s[32:35], s56 offen offset:0 nt
    s_add_u32 s56, s56, s57
    buffer_load_dwordx4 v[200:203], v4, s[32:35], s56 offen offset:0 nt
    s_add_u32 s56, s56, s57
    buffer_load_dwordx4 v[204:207], v4, s[32:35], s56 offen offset:0 nt
    buffer_load_dwordx4 v[208:211], v5, s[32:35], s58 offen offset:1024 nt
    s_add_u32 s58, s58, s57
    buffer_load_dwordx4 v[212:215], v5, s[32:35], s58 offen offset:1024 nt
    s_add_u32 s58, s58, s57
    buffer_load_dwordx4 v[216:219], v5, s[32:35], s58 offen offset:1024 nt
    s_add_u32 s58, s58, s57
    buffer_load_dwordx4 v[220:223], v5, s[32:35], s58 offen offset:1024 nt
    s_add_u32 s58, s58, s57
    buffer_load_dwordx4 v[224:227], v5, s[32:35], s58 offen offset:1024 nt
    s_add_u32 s58, s58, s57
    buffer_load_dwordx4 v[228:231], v5, s[32:35], s58 offen offset:1024 nt
    s_add_u32 s58, s58, s57
    buffer_load_dwordx4 v[232:235], v5, s[32:35], s58 offen offset:1024 nt
    s_add_u32 s58, s58, s57
    buffer_load_dwordx4 v[236:239], v5, s[32:35], s58 offen offset:1024 nt
    s_add_u32 s58, s58, s57
    buffer_load_dwordx4 v[240:243], v5, s[32:35], s58 offen offset:1024 nt
    v_mov_b32 v10, 0
    v_mov_b32 v11, 1
    ds_write_b32 v10, v11 offset:3076
    s_load_dword s77, s[26:27], 32768
    s_mov_b32 s96, 255
    s_not_b32 s97, s96
    s_mov_b32 s40, s26
    s_mov_b32 s41, s27
    s_mov_b32 s42, 2097152
    s_mov_b32 s43, 0x20000
    v_and_b32 v10, 1, v1
    v_lshlrev_b32 v10, 4, v10
    v_mov_b32 v11, 0xffff
    v_lshlrev_b32 v11, v10, v11
    v_bfe_u32 v10, v1, 1, 2
    v_cmp_eq_u32 s[90:91], 0, v10
    v_cmp_eq_u32 s[92:93], 1, v10
    v_cmp_eq_u32 s[94:95], 2, v10
    v_cmp_eq_u32 vcc, 3, v10
    v_cndmask_b32 v14, 0, v11, s[90:91]
    v_cndmask_b32 v15, 0, v11, s[92:93]
    v_cndmask_b32 v16, 0, v11, s[94:95]
    v_cndmask_b32 v17, 0, v11, vcc
    v_and_b32 v11, 7, v1
    v_lshl_add_u32 v10, v8, 3, v11
    s_lshl_b32 s52, s2, 9
    v_lshl_add_u32 v6, v10, 4, s52
    s_lshl_b32 s52, s2, 8
    v_lshl_add_u32 v7, v10, 4, s52
    v_mov_b32 v11, 0x40000000
    s_mov_b32 vcc_lo, 0x00ff00ff
    s_mov_b32 vcc_hi, 0x00ff00ff
    v_cndmask_b32 v6, v11, v6, vcc
    s_mov_b32 vcc_hi, 0
    v_cndmask_b32 v7, v11, v7, vcc
    v_mul_u32_u24 v56, 288, v8
    s_mul_i32 s52, s54, 72
    v_add_u32 v56, s52, v56
    v_add_u32 v57, 1152, v56
    s_mul_i32 s52, s29, 36
    v_add_u32 v10, s52, v8
    v_and_b32 v11, 7, v10
    v_mul_u32_u24 v11, 288, v11
    v_lshrrev_b32 v13, 3, v10
    v_lshl_add_u32 v58, v13, 2, v11
    v_add_u32 v10, 4, v10
    v_and_b32 v11, 7, v10
    v_mul_u32_u24 v11, 288, v11
    v_lshrrev_b32 v13, 3, v10
    v_lshl_add_u32 v59, v13, 2, v11
    s_mov_b32 s52, 786432
    s_mov_b32 s53, 917504
    s_waitcnt lgkmcnt(0)
    s_add_u32 s77, s77, 1
    s_and_b32 s76, s77, s96
    v_mov_b32 v19, s76
    v_mov_b32 v10, 0
    s_mov_b32 s76, 400000
L_lw3:
    ds_read_b32 v11, v10 offset:3072
    s_waitcnt lgkmcnt(0)
    v_cmp_gt_u32 vcc, 1, v11
    s_cbranch_vccz L_lwd4
    s_sub_u32 s76, s76, 1
    s_cbranch_scc1 L_lwd4
    s_sleep 1
    s_branch L_lw3
L_lwd4:
    ds_read_b64 v[244:245], v56 offset:0
    ds_read_b64 v[250:251], v57 offset:0
    ds_read_b64 v[246:247], v56 offset:8
    ds_read_b64 v[252:253], v57 offset:8
    ds_read_b64 v[248:249], v56 offset:16
    ds_read_b64 v[254:255], v57 offset:16
    s_waitcnt lgkmcnt(0)
    ds_read_b64 v[20:21], v56 offset:24
    ds_read_b64 v[26:27], v57 offset:24
    ds_read_b64 v[22:23], v56 offset:32
    ds_read_b64 v[28:29], v57 offset:32
    ds_read_b64 v[24:25], v56 offset:40
    ds_read_b64 v[30:31], v57 offset:40
    v_and_b32 v32, v244, v14
    v_and_b32 v33, v244, v15
    v_and_b32 v34, v244, v16
    v_and_b32 v35, v244, v17
    s_waitcnt vmcnt(44)
    s_nop 0
    v_mfma_f32_16x16x32_bf16 v[48:51], v[64:67], v[32:35], 0
    v_and_b32 v36, v250, v14
    v_and_b32 v37, v250, v15
    v_and_b32 v38, v250, v16
    v_and_b32 v39, v250, v17
    s_waitcnt vmcnt(43)
    s_nop 0
    v_mfma_f32_16x16x32_bf16 v[48:51], v[68:71], v[36:39], v[48:51]
    v_and_b32 v40, v245, v14
    v_and_b32 v41, v245, v15
    v_and_b32 v42, v245, v16
    v_and_b32 v43, v245, v17
    s_waitcnt vmcnt(42)
    s_nop 0
    v_mfma_f32_16x16x32_bf16 v[48:51], v[72:75], v[40:43], v[48:51]
    v_and_b32 v44, v251, v14
    v_and_b32 v45, v251, v15
    v_and_b32 v46, v251, v16
    v_and_b32 v47, v251, v17
    s_waitcnt vmcnt(41)
    s_nop 0
    v_mfma_f32_16x16x32_bf16 v[48:51], v[76:79], v[44:47], v[48:51]
    v_and_b32 v32, v246, v14
    v_and_b32 v33, v246, v15
    v_and_b32 v34, v246, v16
    v_and_b32 v35, v246, v17
    s_waitcnt vmcnt(40)
    s_nop 0
    v_mfma_f32_16x16x32_bf16 v[48:51], v[80:83], v[32:35], v[48:51]
    v_and_b32 v36, v252, v14
    v_and_b32 v37, v252, v15
    v_and_b32 v38, v252, v16
    v_and_b32 v39, v252, v17
    s_waitcnt vmcnt(39)
    s_nop 0
    v_mfma_f32_16x16x32_bf16 v[48:51], v[84:87], v[36:39], v[48:51]
    v_and_b32 v40, v247, v14
    v_and_b32 v41, v247, v15
    v_and_b32 v42, v247, v16
    v_and_b32 v43, v247, v17
    s_waitcnt vmcnt(38)
    s_nop 0
    v_mfma_f32_16x16x32_bf16 v[48:51], v[88:91], v[40:43], v[48:51]
    v_and_b32 v44, v253, v14
    v_and_b32 v45, v253, v15
    v_and_b32 v46, v253, v16
    v_and_b32 v47, v253, v17
    s_waitcnt vmcnt(37)
    s_nop 0
    v_mfma_f32_16x16x32_bf16 v[48:51], v[92:95], v[44:47], v[48:51]
    v_and_b32 v32, v248, v14
    v_and_b32 v33, v248, v15
    v_and_b32 v34, v248, v16
    v_and_b32 v35, v248, v17
    s_waitcnt vmcnt(36)
    s_nop 0
    v_mfma_f32_16x16x32_bf16 v[48:51], v[96:99], v[32:35], v[48:51]
    v_and_b32 v36, v254, v14
    v_and_b32 v37, v254, v15
    v_and_b32 v38, v254, v16
    v_and_b32 v39, v254, v17
    s_waitcnt vmcnt(35)
    s_nop 0
    v_mfma_f32_16x16x32_bf16 v[48:51], v[100:103], v[36:39], v[48:51]
    v_and_b32 v40, v249, v14
    v_and_b32 v41, v249, v15
    v_and_b32 v42, v249, v16
    v_and_b32 v43, v249, v17
    s_waitcnt vmcnt(34)
    s_nop 0
    v_mfma_f32_16x16x32_bf16 v[48:51], v[104:107], v[40:43], v[48:51]
    v_and_b32 v44, v255, v14
    v_and_b32 v45, v255, v15
    v_and_b32 v46, v255, v16
    v_and_b32 v47, v255, v17
    s_waitcnt vmcnt(33)
    s_nop 0
    v_mfma_f32_16x16x32_bf16 v[48:51], v[108:111], v[44:47], v[48:51]
    s_waitcnt lgkmcnt(0)
    ds_read_b64 v[244:245], v56 offset:48
    ds_read_b64 v[250:251], v57 offset:48
    ds_read_b64 v[246:247], v56 offset:56
    ds_read_b64 v[252:253], v57 offset:56
    ds_read_b64 v[248:249], v56 offset:64
    ds_read_b64 v[254:255], v57 offset:64
    v_and_b32 v32, v20, v14
    v_and_b32 v33, v20, v15
    v_and_b32 v34, v20, v16
    v_and_b32 v35, v20, v17
    s_waitcnt vmcnt(32)
    s_nop 0
    v_mfma_f32_16x16x32_bf16 v[48:51], v[112:115], v[32:35], v[48:51]
    v_and_b32 v36, v26, v14
    v_and_b32 v37, v26, v15
    v_and_b32 v38, v26, v16
    v_and_b32 v39, v26, v17
    s_waitcnt vmcnt(31)
    s_nop 0
    v_mfma_f32_16x16x32_bf16 v[48:51], v[116:119], v[36:39], v[48:51]
    v_and_b32 v40, v21, v14
    v_and_b32 v41, v21, v15
    v_and_b32 v42, v21, v16
    v_and_b32 v43, v21, v17
    s_waitcnt vmcnt(30)
    s_nop 0
    v_mfma_f32_16x16x32_bf16 v[48:51], v[120:123], v[40:43], v[48:51]
    v_and_b32 v44, v27, v14
    v_and_b32 v45, v27, v15
    v_and_b32 v46, v27, v16
    v_and_b32 v47, v27, v17
    s_waitcnt vmcnt(29)
    s_nop 0
    v_mfma_f32_16x16x32_bf16 v[48:51], v[124:127], v[44:47], v[48:51]
    v_and_b32 v32, v22, v14
    v_and_b32 v33, v22, v15
    v_and_b32 v34, v22, v16
    v_and_b32 v35, v22, v17
    s_waitcnt vmcnt(28)
    s_nop 0
    v_mfma_f32_16x16x32_bf16 v[48:51], v[128:131], v[32:35], v[48:51]
    v_and_b32 v36, v28, v14
    v_and_b32 v37, v28, v15
    v_and_b32 v38, v28, v16
    v_and_b32 v39, v28, v17
    s_waitcnt vmcnt(27)
    s_nop 0
    v_mfma_f32_16x16x32_bf16 v[48:51], v[132:135], v[36:39], v[48:51]
    v_and_b32 v40, v23, v14
    v_and_b32 v41, v23, v15
    v_and_b32 v42, v23, v16
    v_and_b32 v43, v23, v17
    s_waitcnt vmcnt(26)
    s_nop 0
    v_mfma_f32_16x16x32_bf16 v[48:51], v[136:139], v[40:43], v[48:51]
    v_and_b32 v44, v29, v14
    v_and_b32 v45, v29, v15
    v_and_b32 v46, v29, v16
    v_and_b32 v47, v29, v17
    s_waitcnt vmcnt(25)
    s_nop 0
    v_mfma_f32_16x16x32_bf16 v[48:51], v[140:143], v[44:47], v[48:51]
    v_and_b32 v32, v24, v14
    v_and_b32 v33, v24, v15
    v_and_b32 v34, v24, v16
    v_and_b32 v35, v24, v17
    s_waitcnt vmcnt(24)
    s_nop 0
    v_mfma_f32_16x16x32_bf16 v[48:51], v[144:147], v[32:35], v[48:51]
    v_and_b32 v36, v30, v14
    v_and_b32 v37, v30, v15
    v_and_b32 v38, v30, v16
    v_and_b32 v39, v30, v17
    s_waitcnt vmcnt(23)
    s_nop 0
    v_mfma_f32_16x16x32_bf16 v[48:51], v[148:151], v[36:39], v[48:51]
    v_and_b32 v40, v25, v14
    v_and_b32 v41, v25, v15
    v_and_b32 v42, v25, v16
    v_and_b32 v43, v25, v17
    s_waitcnt vmcnt(22)
    s_nop 0
    v_mfma_f32_16x16x32_bf16 v[48:51], v[152:155], v[40:43], v[48:51]
    v_and_b32 v44, v31, v14
    v_and_b32 v45, v31, v15
    v_and_b32 v46, v31, v16
    v_and_b32 v47, v31, v17
    s_waitcnt vmcnt(21)
    s_nop 0
    v_mfma_f32_16x16x32_bf16 v[48:51], v[156:159], v[44:47], v[48:51]
    s_waitcnt lgkmcnt(0)
    ds_read_b32 v20, v58 offset:0
    ds_read_b32 v21, v59 offset:0
    ds_read_b32 v22, v58 offset:4
    ds_read_b32 v23, v59 offset:4
    ds_read_b32 v24, v58 offset:8
    ds_read_b32 v25, v59 offset:8
    ds_read_b32 v26, v58 offset:12
    ds_read_b32 v27, v59 offset:12
    ds_read_b32 v28, v58 offset:16
    v_and_b32 v32, v244, v14
    v_and_b32 v33, v244, v15
    v_and_b32 v34, v244, v16
    v_and_b32 v35, v244, v17
    s_waitcnt vmcnt(20)
    s_nop 0
    v_mfma_f32_16x16x32_bf16 v[48:51], v[160:163], v[32:35], v[48:51]
    v_and_b32 v36, v250, v14
    v_and_b32 v37, v250, v15
    v_and_b32 v38, v250, v16
    v_and_b32 v39, v250, v17
    s_waitcnt vmcnt(19)
    s_nop 0
    v_mfma_f32_16x16x32_bf16 v[48:51], v[164:167], v[36:39], v[48:51]
    v_and_b32 v40, v245, v14
    v_and_b32 v41, v245, v15
    v_and_b32 v42, v245, v16
    v_and_b32 v43, v245, v17
    s_waitcnt vmcnt(18)
    s_nop 0
    v_mfma_f32_16x16x32_bf16 v[48:51], v[168:171], v[40:43], v[48:51]
    v_and_b32 v44, v251, v14
    v_and_b32 v45, v251, v15
    v_and_b32 v46, v251, v16
    v_and_b32 v47, v251, v17
    s_waitcnt vmcnt(17)
    s_nop 0
    v_mfma_f32_16x16x32_bf16 v[48:51], v[172:175], v[44:47], v[48:51]
    v_and_b32 v32, v246, v14
    v_and_b32 v33, v246, v15
    v_and_b32 v34, v246, v16
    v_and_b32 v35, v246, v17
    s_waitcnt vmcnt(16)
    s_nop 0
    v_mfma_f32_16x16x32_bf16 v[48:51], v[176:179], v[32:35], v[48:51]
    v_and_b32 v36, v252, v14
    v_and_b32 v37, v252, v15
    v_and_b32 v38, v252, v16
    v_and_b32 v39, v252, v17
    s_waitcnt vmcnt(15)
    s_nop 0
    v_mfma_f32_16x16x32_bf16 v[48:51], v[180:183], v[36:39], v[48:51]
    v_and_b32 v40, v247, v14
    v_and_b32 v41, v247, v15
    v_and_b32 v42, v247, v16
    v_and_b32 v43, v247, v17
    s_waitcnt vmcnt(14)
    s_nop 0
    v_mfma_f32_16x16x32_bf16 v[48:51], v[184:187], v[40:43], v[48:51]
    v_and_b32 v44, v253, v14
    v_and_b32 v45, v253, v15
    v_and_b32 v46, v253, v16
    v_and_b32 v47, v253, v17
    s_waitcnt vmcnt(13)
    s_nop 0
    v_mfma_f32_16x16x32_bf16 v[48:51], v[188:191], v[44:47], v[48:51]
    v_and_b32 v32, v248, v14
    v_and_b32 v33, v248, v15
    v_and_b32 v34, v248, v16
    v_and_b32 v35, v248, v17
    s_waitcnt vmcnt(12)
    s_nop 0
    v_mfma_f32_16x16x32_bf16 v[48:51], v[192:195], v[32:35], v[48:51]
    v_and_b32 v36, v254, v14
    v_and_b32 v37, v254, v15
    v_and_b32 v38, v254, v16
    v_and_b32 v39, v254, v17
    s_waitcnt vmcnt(11)
    s_nop 0
    v_mfma_f32_16x16x32_bf16 v[48:51], v[196:199], v[36:39], v[48:51]
    v_and_b32 v40, v249, v14
    v_and_b32 v41, v249, v15
    v_and_b32 v42, v249, v16
    v_and_b32 v43, v249, v17
    s_waitcnt vmcnt(10)
    s_nop 0
    v_mfma_f32_16x16x32_bf16 v[48:51], v[200:203], v[40:43], v[48:51]
    v_and_b32 v44, v255, v14
    v_and_b32 v45, v255, v15
    v_and_b32 v46, v255, v16
    v_and_b32 v47, v255, v17
    s_waitcnt vmcnt(9)
    s_nop 0
    v_mfma_f32_16x16x32_bf16 v[48:51], v[204:207], v[44:47], v[48:51]
    s_waitcnt lgkmcnt(0)
    v_and_b32 v32, v20, v14
    v_and_b32 v33, v20, v15
    v_and_b32 v34, v20, v16
    v_and_b32 v35, v20, v17
    s_waitcnt vmcnt(8)
    s_nop 0
    v_mfma_f32_16x16x32_bf16 v[52:55], v[208:211], v[32:35], 0
    v_and_b32 v36, v21, v14
    v_and_b32 v37, v21, v15
    v_and_b32 v38, v21, v16
    v_and_b32 v39, v21, v17
    s_waitcnt vmcnt(7)
    s_nop 0
    v_mfma_f32_16x16x32_bf16 v[52:55], v[212:215], v[36:39], v[52:55]
    v_and_b32 v40, v22, v14
    v_and_b32 v41, v22, v15
    v_and_b32 v42, v22, v16
    v_and_b32 v43, v22, v17
    s_waitcnt vmcnt(6)
    s_nop 0
    v_mfma_f32_16x16x32_bf16 v[52:55], v[216:219], v[40:43], v[52:55]
    v_and_b32 v44, v23, v14
    v_and_b32 v45, v23, v15
    v_and_b32 v46, v23, v16
    v_and_b32 v47, v23, v17
    s_waitcnt vmcnt(5)
    s_nop 0
    v_mfma_f32_16x16x32_bf16 v[52:55], v[220:223], v[44:47], v[52:55]
    v_and_b32 v32, v24, v14
    v_and_b32 v33, v24, v15
    v_and_b32 v34, v24, v16
    v_and_b32 v35, v24, v17
    s_waitcnt vmcnt(4)
    s_nop 0
    v_mfma_f32_16x16x32_bf16 v[52:55], v[224:227], v[32:35], v[52:55]
    v_and_b32 v36, v25, v14
    v_and_b32 v37, v25, v15
    v_and_b32 v38, v25, v16
    v_and_b32 v39, v25, v17
    s_waitcnt vmcnt(3)
    s_nop 0
    v_mfma_f32_16x16x32_bf16 v[52:55], v[228:231], v[36:39], v[52:55]
    v_and_b32 v40, v26, v14
    v_and_b32 v41, v26, v15
    v_and_b32 v42, v26, v16
    v_and_b32 v43, v26, v17
    s_waitcnt vmcnt(2)
    s_nop 0
    v_mfma_f32_16x16x32_bf16 v[52:55], v[232:235], v[40:43], v[52:55]
    v_and_b32 v44, v27, v14
    v_and_b32 v45, v27, v15
    v_and_b32 v46, v27, v16
    v_and_b32 v47, v27, v17
    s_waitcnt vmcnt(1)
    s_nop 0
    v_mfma_f32_16x16x32_bf16 v[52:55], v[236:239], v[44:47], v[52:55]
    v_and_b32 v32, v28, v14
    v_and_b32 v33, v28, v15
    v_and_b32 v34, v28, v16
    v_and_b32 v35, v28, v17
    s_waitcnt vmcnt(0)
    s_nop 0
    v_mfma_f32_16x16x32_bf16 v[52:55], v[240:243], v[32:35], v[52:55]
    v_and_or_b32 v48, v48, s97, v19
    v_and_or_b32 v49, v49, s97, v19
    v_and_or_b32 v50, v50, s97, v19
    v_and_or_b32 v51, v51, s97, v19
    buffer_store_dwordx4 v[48:51], v6, s[40:43], s52 offen sc1
    s_nop 2
    v_and_or_b32 v52, v52, s97, v19
    v_and_or_b32 v53, v53, s97, v19
    v_and_or_b32 v54, v54, s97, v19
    v_and_or_b32 v55, v55, s97, v19
    buffer_store_dwordx4 v[52:55], v7, s[40:43], s53 offen sc1
    v_mov_b32 v10, 0
    v_mov_b32 v11, 2
    ds_write_b32 v10, v11 offset:3076
    s_endpgm
L_waveT:
    s_lshl_b32 s52, s28, 24
    s_and_b32 s53, s28, 1
    s_lshl_b32 s54, s53, 21
    s_add_u32 s55, s52, s54
    s_xor_b32 s56, s54, 7864320
    s_add_u32 s56, s56, s52
    s_lshr_b32 s57, s29, 2
    s_mul_i32 s58, s57, 1179648
    s_add_u32 s59, s58, 1171456
    s_mul_i32 s60, s57, 1327104
    s_add_u32 s61, s60, 1317888
    s_mul_i32 s62, s29, 331776
    s_lshr_b32 s63, s28, 1
    s_mul_i32 s63, s63, 663552
    s_cmp_eq_u32 s53, 0
    s_waitcnt lgkmcnt(0)
    s_cselect_b32 s64, s16, s18
    s_cselect_b32 s65, s17, s19
    s_load_dword s99, s[10:11], s58
    s_load_dword s99, s[6:7], s55
    s_load_dword s99, s[8:9], s55
    s_load_dword s99, s[6:7], s56
    s_load_dword s99, s[8:9], s56
    s_load_dword s99, s[64:65], s60
    s_load_dword s99, s[10:11], s59
    s_load_dword s99, s[64:65], s61
    s_load_dword s99, s[64:65], s62
    s_load_dword s99, s[20:21], s63
    s_mul_i32 s52, s28, 294912
    s_load_dword s99, s[12:13], s52
    s_barrier
    s_setprio 2
    s_lshr_b32 s30, s28, 1
    s_and_b32 s31, s28, 1
    v_lshrrev_b32 v8, 4, v1
    v_and_b32 v9, 15, v1
    v_mul_u32_u24 v4, 9216, v8
    v_lshl_add_u32 v4, v9, 4, v4
    v_mov_b32 v5, 0x40000000
    v_cmp_gt_u32 vcc, 8, v9
    s_nop 1
    v_cndmask_b32 v5, v5, v4, vcc
    s_and_b32 s58, s2, 31
    s_lshl_b32 s58, s58, 2
    s_lshl_b32 s59, s31, 3
    s_and_b32 s52, s29, 7
    s_add_u32 s59, s59, s52
    s_add_u32 s59, s59, 128
    s_mul_i32 s57, s30, 576
    s_lshr_b32 s54, s29, 3
    s_bfe_u32 s55, s29, 0x20001
    s_and_b32 s56, s29, 1
    s_lshl_b32 s52, s28, 8
    s_lshl_b32 s53, s54, 7
    s_add_u32 s52, s52, s53
    s_lshl_b32 s53, s55, 5
    s_add_u32 s52, s52, s53
    s_lshl_b32 s53, s56, 2
    s_add_u32 s52, s52, s53
    s_mul_i32 s66, s52, 1152
    s_waitcnt lgkmcnt(0)
    s_load_dword s77, s[26:27], 32768
    s_mov_b32 s96, 255
    s_not_b32 s97, s96
    s_mov_b32 s32, s4
    s_mov_b32 s33, s5
    s_mov_b32 s34, 1152
    s_mov_b32 s35, 0x20000
    s_mov_b32 s36, s20
    s_mov_b32 s37, s21
    s_mov_b32 s38, 5308416
    s_mov_b32 s39, 0x20000
    s_mov_b32 s40, s26
    s_mov_b32 s41, s27
    s_mov_b32 s42, 2097152
    s_mov_b32 s43, 0x20000
    s_mov_b32 s44, s12
    s_mov_b32 s45, s13
    s_mov_b32 s46, 4718592
    s_mov_b32 s47, 0x20000
    s_mov_b32 s48, s22
    s_mov_b32 s49, s23
    s_mov_b32 s50, 1152
    s_mov_b32 s51, 0x20000
    v_and_b32 v10, 1, v1
    v_lshlrev_b32 v10, 4, v10
    v_mov_b32 v11, 0xffff
    v_lshlrev_b32 v11, v10, v11
    v_bfe_u32 v10, v1, 1, 2
    v_cmp_eq_u32 s[90:91], 0, v10
    v_cmp_eq_u32 s[92:93], 1, v10
    v_cmp_eq_u32 s[94:95], 2, v10
    v_cmp_eq_u32 vcc, 3, v10
    v_cndmask_b32 v14, 0, v11, s[90:91]
    v_cndmask_b32 v15, 0, v11, s[92:93]
    v_cndmask_b32 v16, 0, v11, s[94:95]
    v_cndmask_b32 v17, 0, v11, vcc
    v_lshrrev_b32 v10, 4, v1
    v_and_b32 v11, 7, v1
    v_lshl_add_u32 v10, v10, 3, v11
    v_lshlrev_b32 v10, 4, v10
    s_mul_i32 s52, s2, 2304
    v_add_u32 v10, s52, v10
    v_mov_b32 v11, 0x40000000
    s_mov_b32 vcc_lo, 0x00ff00ff
    s_mov_b32 vcc_hi, 0x00ff00ff
    v_cndmask_b32 v12, v11, v10, vcc
    s_mov_b32 vcc_hi, 0
    v_cndmask_b32 v13, v11, v10, vcc
    v_bfe_u32 v10, v1, 2, 3
    v_lshlrev_b32 v10, 11, v10
    v_and_b32 v11, 3, v1
    v_lshl_add_u32 v10, v11, 4, v10
    s_lshl_b32 s52, s30, 14
    s_bfe_u32 s53, s2, 0x20003
    s_lshl_b32 s53, s53, 9
    s_add_u32 s52, s52, s53
    s_and_b32 s53, s2, 7
    s_lshl_b32 s53, s53, 6
    s_add_u32 s52, s52, s53
    v_add_u32 v10, s52, v10
    s_lshl_b32 s52, s30, 13
    s_and_b32 s53, s59, 15
    s_lshl_b32 s53, s53, 4
    s_add_u32 s52, s52, s53
    s_add_u32 s52, s52, 131072
    v_and_b32 v11, 31, v1
    v_lshl_add_u32 v11, v11, 8, s52
    v_cmp_gt_u32 vcc, 32, v1
    s_nop 1
    v_cndmask_b32 v28, v11, v10, vcc
    s_mov_b32 s67, 786432
    v_lshrrev_b32 v10, 2, v1
    v_mul_u32_u24 v31, 1152, v10
    v_and_b32 v11, 3, v1
    v_lshl_add_u32 v30, v11, 4, v31
    v_and_b32 v11, 1, v1
    v_mul_u32_u24 v11, 18432, v11
    v_add_u32 v31, v31, v11
    v_and_b32 v11, 1, v1
    s_mul_i32 s54, s2, 2
    s_lshr_b32 s52, s54, 3
    s_lshl_b32 s52, s52, 5
    s_and_b32 s53, s54, 7
    s_add_u32 s52, s52, s53
    v_add_u32 v11, s52, v11
    v_lshlrev_b32 v11, 1, v11
    v_lshl_add_u32 v63, v8, 4, v11
    s_mul_i32 s52, s2, 32
    s_add_u32 s65, s52, 196608
    v_lshrrev_b32 v10, 1, v1
    v_mul_u32_u24 v10, 2304, v10
    v_and_b32 v11, 1, v1
    v_lshl_add_u32 v29, v11, 4, v10
    s_mul_i32 s52, s28, 36864
    s_add_u32 s52, s52, 1376256
    s_lshl_b32 s53, s55, 8
    s_add_u32 s64, s52, s53
    s_lshr_b32 s53, s29, 3
    s_lshl_b32 s74, s53, 7
    s_add_u32 s64, s64, s74
    s_lshl_b32 s74, s56, 6
    s_add_u32 s64, s64, s74
    s_add_u32 s74, s64, 18432
    s_lshl_b32 s53, s53, 4
    s_add_u32 s73, s52, s53
    s_add_u32 s73, s73, 1024
    s_waitcnt lgkmcnt(0)
    s_add_u32 s77, s77, 1
    s_and_b32 s76, s77, s96
    v_mov_b32 v19, s76
    buffer_load_ushort v18, v63, s[32:35], 0 offen
    v_mov_b32 v10, 0
    s_mov_b32 s76, 400000
L_lw5:
    ds_read_b32 v11, v10 offset:3076
    s_waitcnt lgkmcnt(0)
    v_cmp_gt_u32 vcc, 2, v11
    s_cbranch_vccz L_lwd6
    s_sub_u32 s76, s76, 1
    s_cbranch_scc1 L_lwd6
    s_sleep 2
    s_branch L_lw5
L_lwd6:
    s_add_u32 s52, s58, 0
    s_lshr_b32 s53, s52, 3
    s_lshl_b32 s53, s53, 5
    s_and_b32 s52, s52, 7
    s_add_u32 s52, s52, s53
    s_add_u32 s52, s52, s57
    s_mul_i32 s52, s52, 1152
    buffer_load_dwordx4 v[64:67], v4, s[36:39], s52 offen offset:0 nt
    buffer_load_dwordx4 v[68:71], v4, s[36:39], s52 offen offset:256 nt
    buffer_load_dwordx4 v[72:75], v4, s[36:39], s52 offen offset:512 nt
    buffer_load_dwordx4 v[76:79], v4, s[36:39], s52 offen offset:768 nt
    buffer_load_dwordx4 v[80:83], v5, s[36:39], s52 offen offset:1024 nt
    s_add_u32 s52, s58, 1
    s_lshr_b32 s53, s52, 3
    s_lshl_b32 s53, s53, 5
    s_and_b32 s52, s52, 7
    s_add_u32 s52, s52, s53
    s_add_u32 s52, s52, s57
    s_mul_i32 s52, s52, 1152
    buffer_load_dwordx4 v[84:87], v4, s[36:39], s52 offen offset:0 nt
    buffer_load_dwordx4 v[88:91], v4, s[36:39], s52 offen offset:256 nt
    buffer_load_dwordx4 v[92:95], v4, s[36:39], s52 offen offset:512 nt
    buffer_load_dwordx4 v[96:99], v4, s[36:39], s52 offen offset:768 nt
    buffer_load_dwordx4 v[100:103], v5, s[36:39], s52 offen offset:1024 nt
    s_add_u32 s52, s58, 2
    s_lshr_b32 s53, s52, 3
    s_lshl_b32 s53, s53, 5
    s_and_b32 s52, s52, 7
    s_add_u32 s52, s52, s53
    s_add_u32 s52, s52, s57
    s_mul_i32 s52, s52, 1152
    buffer_load_dwordx4 v[104:107], v4, s[36:39], s52 offen offset:0 nt
    buffer_load_dwordx4 v[108:111], v4, s[36:39], s52 offen offset:256 nt
    buffer_load_dwordx4 v[112:115], v4, s[36:39], s52 offen offset:512 nt
    buffer_load_dwordx4 v[116:119], v4, s[36:39], s52 offen offset:768 nt
    buffer_load_dwordx4 v[120:123], v5, s[36:39], s52 offen offset:1024 nt
    s_add_u32 s52, s58, 3
    s_lshr_b32 s53, s52, 3
    s_lshl_b32 s53, s53, 5
    s_and_b32 s52, s52, 7
    s_add_u32 s52, s52, s53
    s_add_u32 s52, s52, s57
    s_mul_i32 s52, s52, 1152
    buffer_load_dwordx4 v[124:127], v4, s[36:39], s52 offen offset:0 nt
    buffer_load_dwordx4 v[128:131], v4, s[36:39], s52 offen offset:256 nt
    buffer_load_dwordx4 v[132:135], v4, s[36:39], s52 offen offset:512 nt
    buffer_load_dwordx4 v[136:139], v4, s[36:39], s52 offen offset:768 nt
    buffer_load_dwordx4 v[140:143], v5, s[36:39], s52 offen offset:1024 nt
    s_cmp_lt_u32 s29, 8
    s_cbranch_scc0 L_dn4
    s_mov_b32 s52, s59
    s_lshr_b32 s53, s52, 3
    s_lshl_b32 s53, s53, 5
    s_and_b32 s52, s52, 7
    s_add_u32 s52, s52, s53
    s_add_u32 s52, s52, s57
    s_mul_i32 s52, s52, 1152
    buffer_load_dwordx4 v[144:147], v4, s[36:39], s52 offen offset:0 nt
    buffer_load_dwordx4 v[148:151], v4, s[36:39], s52 offen offset:256 nt
    buffer_load_dwordx4 v[152:155], v4, s[36:39], s52 offen offset:512 nt
    buffer_load_dwordx4 v[156:159], v4, s[36:39], s52 offen offset:768 nt
    buffer_load_dwordx4 v[160:163], v5, s[36:39], s52 offen offset:1024 nt
L_dn4:
    s_mov_b32 s76, 400000
L_poll7:
    buffer_load_dwordx4 v[48:51], v28, s[40:43], s67 offen sc1
L_poll7_w:
    s_waitcnt vmcnt(0)
L_poll7_c:
    v_xor_b32 v48, v48, v19
    v_xor_b32 v49, v49, v19
    v_xor_b32 v50, v50, v19
    v_xor_b32 v51, v51, v19
    v_or3_b32 v10, v48, v49, v50
    v_mov_b32 v11, v51
    v_or_b32 v10, v10, v11
    v_and_b32 v10, s96, v10
    v_cmp_ne_u32 vcc, 0, v10
    s_cbranch_vccz L_polld8
    s_sub_u32 s76, s76, 1
    s_cbranch_scc1 L_polld8
    s_sleep 8
    s_branch L_poll7
L_polld8:
    v_add_f32_dpp v48, v48, v48 row_ror:8 row_mask:0xf bank_mask:0xf
    v_add_f32_dpp v49, v49, v49 row_ror:8 row_mask:0xf bank_mask:0xf
    v_add_f32_dpp v50, v50, v50 row_ror:8 row_mask:0xf bank_mask:0xf
    v_add_f32_dpp v51, v51, v51 row_ror:8 row_mask:0xf bank_mask:0xf
    v_add_f32_dpp v48, v48, v48 row_ror:4 row_mask:0xf bank_mask:0xf
    v_add_f32_dpp v49, v49, v49 row_ror:4 row_mask:0xf bank_mask:0xf
    v_add_f32_dpp v50, v50, v50 row_ror:4 row_mask:0xf bank_mask:0xf
    v_add_f32_dpp v51, v51, v51 row_ror:4 row_mask:0xf bank_mask:0xf
    v_add_f32_dpp v48, v48, v48 row_ror:2 row_mask:0xc bank_mask:0xf
    v_add_f32_dpp v49, v49, v49 row_ror:2 row_mask:0xc bank_mask:0xf
    v_add_f32_dpp v50, v50, v50 row_ror:2 row_mask:0xc bank_mask:0xf
    v_add_f32_dpp v51, v51, v51 row_ror:2 row_mask:0xc bank_mask:0xf
    v_add_f32_dpp v48, v48, v48 row_ror:1 row_mask:0xc bank_mask:0xf
    v_add_f32_dpp v49, v49, v49 row_ror:1 row_mask:0xc bank_mask:0xf
    v_add_f32_dpp v50, v50, v50 row_ror:1 row_mask:0xc bank_mask:0xf
    v_add_f32_dpp v51, v51, v51 row_ror:1 row_mask:0xc bank_mask:0xf
    v_bfe_u32 v20, v1, 2, 2
    v_cmp_eq_u32 s[90:91], 1, v20
    v_cmp_eq_u32 s[92:93], 2, v20
    v_cmp_eq_u32 vcc, 3, v20
    v_cndmask_b32 v10, v48, v49, s[90:91]
    v_cndmask_b32 v10, v10, v50, s[92:93]
    v_cndmask_b32 v10, v10, v51, vcc
    v_mov_b32 v11, v10
    s_nop 1
    v_permlane16_swap_b32 v10, v11
    v_cvt_pk_bf16_f32 v10, v10, v10
    v_and_b32 v10, 0xffff0000, v10
    v_cvt_pk_bf16_f32 v11, v11, v11
    v_and_b32 v11, 0xffff0000, v11
    v_mul_f32 v10, 0xbfb8aa3b, v10
    v_exp_f32 v10, v10
    s_nop 0
    v_add_f32 v10, 1.0, v10
    v_rcp_f32 v10, v10
    s_nop 0
    v_cvt_pk_bf16_f32 v10, v10, v10
    v_and_b32 v10, 0xffff0000, v10
    v_mul_f32 v10, v10, v11
    v_cvt_pk_bf16_f32 v10, v10, v10
    v_and_b32 v11, 3, v1
    v_cmp_gt_u32 vcc, 32, v1
    s_nop 1
    v_cndmask_b32 v11, 4, v11, vcc
    v_lshlrev_b32 v11, 4, v11
    v_lshl_add_u32 v11, v20, 2, v11
    ds_write_b32 v11, v10 offset:2816
    v_lshlrev_b32 v11, 2, v8
    v_lshlrev_b32 v18, 16, v18
    s_waitcnt lgkmcnt(0)
    ds_read_b32 v52, v11 offset:2816
    ds_read_b32 v53, v11 offset:2832
    ds_read_b32 v62, v11 offset:2848
    ds_read_b32 v26, v11 offset:2864
    ds_read_b32 v27, v11 offset:2880
    s_waitcnt lgkmcnt(0)
    v_and_b32 v32, v52, v14
    v_and_b32 v33, v52, v15
    v_and_b32 v34, v52, v16
    v_and_b32 v35, v52, v17
    s_nop 1
    v_mfma_f32_16x16x32_bf16 v[244:247], v[64:67], v[32:35], 0
    v_mfma_f32_16x16x32_bf16 v[248:251], v[68:71], v[32:35], 0
    v_mfma_f32_16x16x32_bf16 v[252:255], v[72:75], v[32:35], 0
    v_mfma_f32_16x16x32_bf16 v[54:57], v[76:79], v[32:35], 0
    v_mfma_f32_16x16x32_bf16 v[58:61], v[80:83], v[32:35], 0
    v_and_b32 v36, v53, v14
    v_and_b32 v37, v53, v15
    v_and_b32 v38, v53, v16
    v_and_b32 v39, v53, v17
    s_nop 1
    v_mfma_f32_16x16x32_bf16 v[244:247], v[84:87], v[36:39], v[244:247]
    v_mfma_f32_16x16x32_bf16 v[248:251], v[88:91], v[36:39], v[248:251]
    v_mfma_f32_16x16x32_bf16 v[252:255], v[92:95], v[36:39], v[252:255]
    v_mfma_f32_16x16x32_bf16 v[54:57], v[96:99], v[36:39], v[54:57]
    v_mfma_f32_16x16x32_bf16 v[58:61], v[100:103], v[36:39], v[58:61]
    v_and_b32 v32, v62, v14
    v_and_b32 v33, v62, v15
    v_and_b32 v34, v62, v16
    v_and_b32 v35, v62, v17
    s_nop 1
    v_mfma_f32_16x16x32_bf16 v[244:247], v[104:107], v[32:35], v[244:247]
    v_mfma_f32_16x16x32_bf16 v[248:251], v[108:111], v[32:35], v[248:251]
    v_mfma_f32_16x16x32_bf16 v[252:255], v[112:115], v[32:35], v[252:255]
    v_mfma_f32_16x16x32_bf16 v[54:57], v[116:119], v[32:35], v[54:57]
    v_mfma_f32_16x16x32_bf16 v[58:61], v[120:123], v[32:35], v[58:61]
    v_and_b32 v36, v26, v14
    v_and_b32 v37, v26, v15
    v_and_b32 v38, v26, v16
    v_and_b32 v39, v26, v17
    s_nop 1
    v_mfma_f32_16x16x32_bf16 v[244:247], v[124:127], v[36:39], v[244:247]
    v_mfma_f32_16x16x32_bf16 v[248:251], v[128:131], v[36:39], v[248:251]
    v_mfma_f32_16x16x32_bf16 v[252:255], v[132:135], v[36:39], v[252:255]
    v_mfma_f32_16x16x32_bf16 v[54:57], v[136:139], v[36:39], v[54:57]
    v_mfma_f32_16x16x32_bf16 v[58:61], v[140:143], v[36:39], v[58:61]
    s_cmp_lt_u32 s29, 8
    s_cbranch_scc0 L_mm4
    v_and_b32 v32, v27, v14
    v_and_b32 v33, v27, v15
    v_and_b32 v34, v27, v16
    v_and_b32 v35, v27, v17
    s_nop 1
    v_mfma_f32_16x16x32_bf16 v[244:247], v[144:147], v[32:35], v[244:247]
    v_mfma_f32_16x16x32_bf16 v[248:251], v[148:151], v[32:35], v[248:251]
    v_mfma_f32_16x16x32_bf16 v[252:255], v[152:155], v[32:35], v[252:255]
    v_mfma_f32_16x16x32_bf16 v[54:57], v[156:159], v[32:35], v[54:57]
    v_mfma_f32_16x16x32_bf16 v[58:61], v[160:163], v[32:35], v[58:61]
L_mm4:
    s_lshl_b32 s52, s28, 24
    s_add_u32 s53, s52, 16777216
L_pg:
    s_load_dword s99, s[6:7], s52
    s_load_dword s99, s[8:9], s52
    s_add_u32 s52, s52, 2097152
    s_cmp_lt_u32 s52, s53
    s_cbranch_scc1 L_pg
    s_waitcnt lgkmcnt(0)
    s_barrier
    s_mov_b32 s76, 400000
    buffer_load_dwordx4 v[104:107], v31, s[40:43], s73 offen sc1
    buffer_load_dwordx4 v[96:99], v30, s[40:43], s64 offen sc1
    buffer_load_dwordx4 v[100:103], v30, s[40:43], s74 offen sc1
    buffer_load_dwordx4 v[164:167], v4, s[44:47], s66 offen offset:0 nt
    buffer_load_dwordx4 v[168:171], v4, s[44:47], s66 offen offset:256 nt
    buffer_load_dwordx4 v[172:175], v4, s[44:47], s66 offen offset:512 nt
    buffer_load_dwordx4 v[176:179], v4, s[44:47], s66 offen offset:768 nt
    buffer_load_dwordx4 v[180:183], v5, s[44:47], s66 offen offset:1024 nt
    s_add_u32 s66, s66, 1152
    buffer_load_dwordx4 v[184:187], v4, s[44:47], s66 offen offset:0 nt
    buffer_load_dwordx4 v[188:191], v4, s[44:47], s66 offen offset:256 nt
    buffer_load_dwordx4 v[192:195], v4, s[44:47], s66 offen offset:512 nt
    buffer_load_dwordx4 v[196:199], v4, s[44:47], s66 offen offset:768 nt
    buffer_load_dwordx4 v[200:203], v5, s[44:47], s66 offen offset:1024 nt
    s_add_u32 s66, s66, 1152
    buffer_load_dwordx4 v[204:207], v4, s[44:47], s66 offen offset:0 nt
    buffer_load_dwordx4 v[208:211], v4, s[44:47], s66 offen offset:256 nt
    buffer_load_dwordx4 v[212:215], v4, s[44:47], s66 offen offset:512 nt
    buffer_load_dwordx4 v[216:219], v4, s[44:47], s66 offen offset:768 nt
    buffer_load_dwordx4 v[220:223], v5, s[44:47], s66 offen offset:1024 nt
    s_add_u32 s66, s66, 1152
    buffer_load_dwordx4 v[224:227], v4, s[44:47], s66 offen offset:0 nt
    buffer_load_dwordx4 v[228:231], v4, s[44:47], s66 offen offset:256 nt
    buffer_load_dwordx4 v[232:235], v4, s[44:47], s66 offen offset:512 nt
    buffer_load_dwordx4 v[236:239], v4, s[44:47], s66 offen offset:768 nt
    buffer_load_dwordx4 v[240:243], v5, s[44:47], s66 offen offset:1024 nt
    s_waitcnt vmcnt(20)
    s_branch L_poll9_c
L_poll9:
    buffer_load_dwordx4 v[104:107], v31, s[40:43], s73 offen sc1
    buffer_load_dwordx4 v[96:99], v30, s[40:43], s64 offen sc1
    buffer_load_dwordx4 v[100:103], v30, s[40:43], s74 offen sc1
L_poll9_w:
    s_waitcnt vmcnt(0)
L_poll9_c:
    v_xor_b32 v72, v104, v19
    v_xor_b32 v73, v105, v19
    v_xor_b32 v74, v106, v19
    v_max_f32_dpp v2, v72, v72 row_ror:8 row_mask:0xf bank_mask:0xf
    v_xor_b32 v75, v107, v19
    v_xor_b32 v64, v96, v19
    v_xor_b32 v65, v97, v19
    v_max_f32_dpp v2, v2, v2 row_ror:4 row_mask:0xf bank_mask:0xf
    v_xor_b32 v66, v98, v19
    v_xor_b32 v67, v99, v19
    v_xor_b32 v68, v100, v19
    v_max_f32_dpp v2, v2, v2 row_ror:2 row_mask:0xf bank_mask:0xf
    v_xor_b32 v69, v101, v19
    v_xor_b32 v70, v102, v19
    v_xor_b32 v71, v103, v19
    v_max_f32_dpp v2, v2, v2 row_ror:1 row_mask:0xf bank_mask:0xf
    v_or3_b32 v10, v64, v65, v66
    v_or3_b32 v11, v67, v68, v69
    v_or3_b32 v10, v10, v70, v71
    v_mov_b32 v0, v2
    v_or3_b32 v11, v11, v72, v73
    v_or3_b32 v10, v10, v74, v75
    v_permlane16_swap_b32 v2, v0
    v_max_f32 v2, v2, v0
    v_mov_b32 v0, v2
    s_nop 1
    v_permlane32_swap_b32 v2, v0
    v_max_f32 v2, v2, v0
    v_sub_f32 v2, v72, v2
    v_exp_f32 v2, v2
    v_or_b32 v10, v10, v11
    v_and_b32 v10, s96, v10
    v_cmp_ne_u32 vcc, 0, v10
    s_cbranch_vccz L_polld10
    s_sub_u32 s76, s76, 1
    s_cbranch_scc1 L_polld10
    s_sleep 1
    s_branch L_poll9
L_polld10:
    v_mul_f32 v24, v2, v73
    v_mul_f32_dpp v20, v2, v64 quad_perm:[0,0,0,0] row_mask:0xf bank_mask:0xf
    v_mul_f32_dpp v21, v2, v65 quad_perm:[0,0,0,0] row_mask:0xf bank_mask:0xf
    v_add_f32_dpp v24, v24, v24 row_ror:8 row_mask:0xf bank_mask:0xf
    v_mul_f32_dpp v22, v2, v66 quad_perm:[0,0,0,0] row_mask:0xf bank_mask:0xf
    v_mul_f32_dpp v23, v2, v67 quad_perm:[0,0,0,0] row_mask:0xf bank_mask:0xf
    v_add_f32_dpp v24, v24, v24 row_ror:4 row_mask:0xf bank_mask:0xf
    v_fmac_f32_dpp v20, v2, v68 quad_perm:[1,1,1,1] row_mask:0xf bank_mask:0xf
    v_fmac_f32_dpp v21, v2, v69 quad_perm:[1,1,1,1] row_mask:0xf bank_mask:0xf
    v_add_f32_dpp v24, v24, v24 row_ror:2 row_mask:0xf bank_mask:0xf
    v_fmac_f32_dpp v22, v2, v70 quad_perm:[1,1,1,1] row_mask:0xf bank_mask:0xf
    v_fmac_f32_dpp v23, v2, v71 quad_perm:[1,1,1,1] row_mask:0xf bank_mask:0xf
    v_add_f32_dpp v24, v24, v24 row_ror:1 row_mask:0xf bank_mask:0xf
    v_mov_b32 v25, v24
    s_nop 1
    v_permlane16_swap_b32 v24, v25
    v_add_f32 v24, v24, v25
    v_mov_b32 v25, v24
    s_nop 1
    v_permlane32_swap_b32 v24, v25
    v_add_f32 v24, v24, v25
    v_mul_f32 v24, 0.5, v24
    v_rcp_f32 v24, v24
    v_permlane16_swap_b32 v20, v21
    v_permlane16_swap_b32 v22, v23
    v_add_f32 v20, v20, v21
    v_add_f32 v22, v22, v23
    s_nop 1
    v_permlane32_swap_b32 v20, v22
    v_add_f32 v20, v20, v22
    s_nop 1
    v_add_f32_dpp v20, v20, v20 row_ror:8 row_mask:0xf bank_mask:0xf
    s_nop 1
    v_add_f32_dpp v20, v20, v20 row_ror:4 row_mask:0xf bank_mask:0xf
    v_mul_f32 v20, v20, v24
    v_cvt_pk_bf16_f32 v20, v20, v20
    s_nop 1
    v_and_b32_dpp v32, v20, v14 quad_perm:[0,0,0,0] row_mask:0xf bank_mask:0xf
    v_and_b32_dpp v33, v20, v15 quad_perm:[0,0,0,0] row_mask:0xf bank_mask:0xf
    v_and_b32_dpp v34, v20, v16 quad_perm:[0,0,0,0] row_mask:0xf bank_mask:0xf
    v_and_b32_dpp v35, v20, v17 quad_perm:[0,0,0,0] row_mask:0xf bank_mask:0xf
    v_and_b32_dpp v36, v20, v14 quad_perm:[1,1,1,1] row_mask:0xf bank_mask:0xf
    v_and_b32_dpp v37, v20, v15 quad_perm:[1,1,1,1] row_mask:0xf bank_mask:0xf
    v_and_b32_dpp v38, v20, v16 quad_perm:[1,1,1,1] row_mask:0xf bank_mask:0xf
    v_and_b32_dpp v39, v20, v17 quad_perm:[1,1,1,1] row_mask:0xf bank_mask:0xf
    v_and_b32_dpp v40, v20, v14 quad_perm:[2,2,2,2] row_mask:0xf bank_mask:0xf
    v_and_b32_dpp v41, v20, v15 quad_perm:[2,2,2,2] row_mask:0xf bank_mask:0xf
    v_and_b32_dpp v42, v20, v16 quad_perm:[2,2,2,2] row_mask:0xf bank_mask:0xf
    v_and_b32_dpp v43, v20, v17 quad_perm:[2,2,2,2] row_mask:0xf bank_mask:0xf
    v_and_b32_dpp v44, v20, v14 quad_perm:[3,3,3,3] row_mask:0xf bank_mask:0xf
    v_and_b32_dpp v45, v20, v15 quad_perm:[3,3,3,3] row_mask:0xf bank_mask:0xf
    v_and_b32_dpp v46, v20, v16 quad_perm:[3,3,3,3] row_mask:0xf bank_mask:0xf
    v_and_b32_dpp v47, v20, v17 quad_perm:[3,3,3,3] row_mask:0xf bank_mask:0xf
    s_waitcnt vmcnt(0)
    v_mfma_f32_16x16x32_bf16 v[244:247], v[164:167], v[32:35], v[244:247]
    v_mfma_f32_16x16x32_bf16 v[244:247], v[184:187], v[36:39], v[244:247]
    v_mfma_f32_16x16x32_bf16 v[244:247], v[204:207], v[40:43], v[244:247]
    v_mfma_f32_16x16x32_bf16 v[244:247], v[224:227], v[44:47], v[244:247]
    v_mfma_f32_16x16x32_bf16 v[248:251], v[168:171], v[32:35], v[248:251]
    v_mfma_f32_16x16x32_bf16 v[248:251], v[188:191], v[36:39], v[248:251]
    v_mfma_f32_16x16x32_bf16 v[248:251], v[208:211], v[40:43], v[248:251]
    v_mfma_f32_16x16x32_bf16 v[248:251], v[228:231], v[44:47], v[248:251]
    s_nop 3
    v_and_or_b32 v244, v244, s97, v19
    v_and_or_b32 v245, v245, s97, v19
    v_and_or_b32 v246, v246, s97, v19
    v_and_or_b32 v247, v247, s97, v19
    s_mov_b32 s53, 196608
    buffer_store_dwordx4 v[244:247], v12, s[40:43], s53 offen sc1
    v_mfma_f32_16x16x32_bf16 v[252:255], v[172:175], v[32:35], v[252:255]
    v_mfma_f32_16x16x32_bf16 v[252:255], v[192:195], v[36:39], v[252:255]
    v_mfma_f32_16x16x32_bf16 v[252:255], v[212:215], v[40:43], v[252:255]
    v_mfma_f32_16x16x32_bf16 v[252:255], v[232:235], v[44:47], v[252:255]
    v_and_or_b32 v248, v248, s97, v19
    v_and_or_b32 v249, v249, s97, v19
    v_and_or_b32 v250, v250, s97, v19
    v_and_or_b32 v251, v251, s97, v19
    s_mov_b32 s53, 197120
    buffer_store_dwordx4 v[248:251], v12, s[40:43], s53 offen sc1
    v_mfma_f32_16x16x32_bf16 v[54:57], v[176:179], v[32:35], v[54:57]
    v_mfma_f32_16x16x32_bf16 v[54:57], v[196:199], v[36:39], v[54:57]
    v_mfma_f32_16x16x32_bf16 v[54:57], v[216:219], v[40:43], v[54:57]
    v_mfma_f32_16x16x32_bf16 v[54:57], v[236:239], v[44:47], v[54:57]
    v_and_or_b32 v252, v252, s97, v19
    v_and_or_b32 v253, v253, s97, v19
    v_and_or_b32 v254, v254, s97, v19
    v_and_or_b32 v255, v255, s97, v19
    s_mov_b32 s53, 197632
    buffer_store_dwordx4 v[252:255], v12, s[40:43], s53 offen sc1
    v_mfma_f32_16x16x32_bf16 v[58:61], v[180:183], v[32:35], v[58:61]
    v_mfma_f32_16x16x32_bf16 v[58:61], v[200:203], v[36:39], v[58:61]
    v_mfma_f32_16x16x32_bf16 v[58:61], v[220:223], v[40:43], v[58:61]
    v_mfma_f32_16x16x32_bf16 v[58:61], v[240:243], v[44:47], v[58:61]
    v_and_or_b32 v54, v54, s97, v19
    v_and_or_b32 v55, v55, s97, v19
    v_and_or_b32 v56, v56, s97, v19
    v_and_or_b32 v57, v57, s97, v19
    s_mov_b32 s53, 198144
    buffer_store_dwordx4 v[54:57], v12, s[40:43], s53 offen sc1
    s_nop 1
    v_and_or_b32 v58, v58, s97, v19
    v_and_or_b32 v59, v59, s97, v19
    v_and_or_b32 v60, v60, s97, v19
    v_and_or_b32 v61, v61, s97, v19
    s_mov_b32 s53, 198656
    buffer_store_dwordx4 v[58:61], v13, s[40:43], s53 offen sc1
    s_cmp_ge_u32 s2, 72
    s_cbranch_scc1 L_tdone
    s_add_u32 s5, s65, 73728
    s_add_u32 s6, s65, 147456
    s_add_u32 s7, s65, 221184
    s_add_u32 s8, s65, 294912
    s_add_u32 s9, s65, 368640
    s_add_u32 s10, s65, 442368
    s_add_u32 s11, s65, 516096
    s_mov_b32 s76, 400000
    buffer_load_dwordx4 v[96:99], v29, s[40:43], s65 offen sc1
    buffer_load_dwordx4 v[100:103], v29, s[40:43], s5 offen sc1
    buffer_load_dwordx4 v[104:107], v29, s[40:43], s6 offen sc1
    buffer_load_dwordx4 v[108:111], v29, s[40:43], s7 offen sc1
    buffer_load_dwordx4 v[112:115], v29, s[40:43], s8 offen sc1
    buffer_load_dwordx4 v[116:119], v29, s[40:43], s9 offen sc1
    buffer_load_dwordx4 v[120:123], v29, s[40:43], s10 offen sc1
    buffer_load_dwordx4 v[124:127], v29, s[40:43], s11 offen sc1
L_poll11:
    buffer_load_dwordx4 v[128:131], v29, s[40:43], s65 offen sc1
    buffer_load_dwordx4 v[132:135], v29, s[40:43], s5 offen sc1
    buffer_load_dwordx4 v[136:139], v29, s[40:43], s6 offen sc1
    buffer_load_dwordx4 v[140:143], v29, s[40:43], s7 offen sc1
    buffer_load_dwordx4 v[144:147], v29, s[40:43], s8 offen sc1
    buffer_load_dwordx4 v[148:151], v29, s[40:43], s9 offen sc1
    buffer_load_dwordx4 v[152:155], v29, s[40:43], s10 offen sc1
    buffer_load_dwordx4 v[156:159], v29, s[40:43], s11 offen sc1
L_poll11_w:
    s_waitcnt vmcnt(8)
L_poll11_c:
    v_xor_b32 v64, v96, v19
    v_xor_b32 v65, v97, v19
    v_xor_b32 v66, v98, v19
    v_xor_b32 v67, v99, v19
    v_xor_b32 v68, v100, v19
    v_xor_b32 v69, v101, v19
    v_xor_b32 v70, v102, v19
    v_xor_b32 v71, v103, v19
    v_xor_b32 v72, v104, v19
    v_xor_b32 v73, v105, v19
    v_xor_b32 v74, v106, v19
    v_xor_b32 v75, v107, v19
    v_xor_b32 v76, v108, v19
    v_xor_b32 v77, v109, v19
    v_xor_b32 v78, v110, v19
    v_xor_b32 v79, v111, v19
    v_xor_b32 v80, v112, v19
    v_xor_b32 v81, v113, v19
    v_xor_b32 v82, v114, v19
    v_xor_b32 v83, v115, v19
    v_xor_b32 v84, v116, v19
    v_xor_b32 v85, v117, v19
    v_xor_b32 v86, v118, v19
    v_xor_b32 v87, v119, v19
    v_xor_b32 v88, v120, v19
    v_xor_b32 v89, v121, v19
    v_xor_b32 v90, v122, v19
    v_xor_b32 v91, v123, v19
    v_xor_b32 v92, v124, v19
    v_xor_b32 v93, v125, v19
    v_xor_b32 v94, v126, v19
    v_xor_b32 v95, v127, v19
    v_or3_b32 v10, v64, v65, v66
    v_or3_b32 v11, v67, v68, v69
    v_or3_b32 v10, v10, v70, v71
    v_or3_b32 v11, v11, v72, v73
    v_or3_b32 v10, v10, v74, v75
    v_or3_b32 v11, v11, v76, v77
    v_or3_b32 v10, v10, v78, v79
    v_or3_b32 v11, v11, v80, v81
    v_or3_b32 v10, v10, v82, v83
    v_or3_b32 v11, v11, v84, v85
    v_or3_b32 v10, v10, v86, v87
    v_or3_b32 v11, v11, v88, v89
    v_or3_b32 v10, v10, v90, v91
    v_or3_b32 v11, v11, v92, v93
    v_or3_b32 v10, v10, v94, v95
    v_or_b32 v10, v10, v11
    v_and_b32 v10, s96, v10
    v_cmp_ne_u32 vcc, 0, v10
    s_cbranch_vccz L_polld12
    buffer_load_dwordx4 v[96:99], v29, s[40:43], s65 offen sc1
    buffer_load_dwordx4 v[100:103], v29, s[40:43], s5 offen sc1
    buffer_load_dwordx4 v[104:107], v29, s[40:43], s6 offen sc1
    buffer_load_dwordx4 v[108:111], v29, s[40:43], s7 offen sc1
    buffer_load_dwordx4 v[112:115], v29, s[40:43], s8 offen sc1
    buffer_load_dwordx4 v[116:119], v29, s[40:43], s9 offen sc1
    buffer_load_dwordx4 v[120:123], v29, s[40:43], s10 offen sc1
    buffer_load_dwordx4 v[124:127], v29, s[40:43], s11 offen sc1
    s_waitcnt vmcnt(8)
    v_xor_b32 v64, v128, v19
    v_xor_b32 v65, v129, v19
    v_xor_b32 v66, v130, v19
    v_xor_b32 v67, v131, v19
    v_xor_b32 v68, v132, v19
    v_xor_b32 v69, v133, v19
    v_xor_b32 v70, v134, v19
    v_xor_b32 v71, v135, v19
    v_xor_b32 v72, v136, v19
    v_xor_b32 v73, v137, v19
    v_xor_b32 v74, v138, v19
    v_xor_b32 v75, v139, v19
    v_xor_b32 v76, v140, v19
    v_xor_b32 v77, v141, v19
    v_xor_b32 v78, v142, v19
    v_xor_b32 v79, v143, v19
    v_xor_b32 v80, v144, v19
    v_xor_b32 v81, v145, v19
    v_xor_b32 v82, v146, v19
    v_xor_b32 v83, v147, v19
    v_xor_b32 v84, v148, v19
    v_xor_b32 v85, v149, v19
    v_xor_b32 v86, v150, v19
    v_xor_b32 v87, v151, v19
    v_xor_b32 v88, v152, v19
    v_xor_b32 v89, v153, v19
    v_xor_b32 v90, v154, v19
    v_xor_b32 v91, v155, v19
    v_xor_b32 v92, v156, v19
    v_xor_b32 v93, v157, v19
    v_xor_b32 v94, v158, v19
    v_xor_b32 v95, v159, v19
    v_or3_b32 v10, v64, v65, v66
    v_or3_b32 v11, v67, v68, v69
    v_or3_b32 v10, v10, v70, v71
    v_or3_b32 v11, v11, v72, v73
    v_or3_b32 v10, v10, v74, v75
    v_or3_b32 v11, v11, v76, v77
    v_or3_b32 v10, v10, v78, v79
    v_or3_b32 v11, v11, v80, v81
    v_or3_b32 v10, v10, v82, v83
    v_or3_b32 v11, v11, v84, v85
    v_or3_b32 v10, v10, v86, v87
    v_or3_b32 v11, v11, v88, v89
    v_or3_b32 v10, v10, v90, v91
    v_or3_b32 v11, v11, v92, v93
    v_or3_b32 v10, v10, v94, v95
    v_or_b32 v10, v10, v11
    v_and_b32 v10, s96, v10
    v_cmp_ne_u32 vcc, 0, v10
    s_cbranch_vccz L_polld12
    s_sub_u32 s76, s76, 1
    s_cbranch_scc1 L_polld12
    s_branch L_poll11
L_polld12:
    v_pk_add_f32 v[20:21], v[64:65], v[72:73]
    v_pk_add_f32 v[22:23], v[66:67], v[74:75]
    v_pk_add_f32 v[24:25], v[68:69], v[76:77]
    v_pk_add_f32 v[26:27], v[70:71], v[78:79]
    v_pk_add_f32 v[20:21], v[20:21], v[80:81]
    v_pk_add_f32 v[22:23], v[22:23], v[82:83]
    v_pk_add_f32 v[24:25], v[24:25], v[84:85]
    v_pk_add_f32 v[26:27], v[26:27], v[86:87]
    v_pk_add_f32 v[20:21], v[20:21], v[88:89]
    v_pk_add_f32 v[22:23], v[22:23], v[90:91]
    v_pk_add_f32 v[24:25], v[24:25], v[92:93]
    v_pk_add_f32 v[26:27], v[26:27], v[94:95]
    v_pk_add_f32 v[20:21], v[20:21], v[24:25]
    v_pk_add_f32 v[22:23], v[22:23], v[26:27]
    s_nop 0
    v_permlane16_swap_b32 v20, v21
    v_permlane16_swap_b32 v22, v23
    v_add_f32 v20, v20, v21
    v_add_f32 v22, v22, v23
    s_nop 1
    v_permlane32_swap_b32 v20, v22
    v_add_f32 v20, v20, v22
    s_nop 1
    v_add_f32_dpp v20, v20, v20 row_ror:8 row_mask:0xf bank_mask:0xf
    s_nop 1
    v_add_f32_dpp v20, v20, v20 row_ror:4 row_mask:0xf bank_mask:0xf
    s_nop 1
    v_add_f32_dpp v20, v20, v20 row_ror:2 row_mask:0xf bank_mask:0xf
    v_add_f32 v10, v18, v20
    v_cvt_pk_bf16_f32 v10, v10, v10
    s_mov_b32 exec_lo, 0x30003
    s_mov_b32 exec_hi, 0x30003
    buffer_store_short v10, v63, s[48:51], 0 offen sc1
L_tdone:
    s_cmp_lg_u32 s2, 0
    s_cbranch_scc1 L_end
    s_mov_b64 exec, 1
    s_mov_b32 s98, 32768
    v_mov_b32 v10, s77
    buffer_store_dword v10, v3, s[40:43], s98 offen sc1
    s_endpgm
L_stream:
    v_and_b32 v10, 3, v1
    v_bfe_u32 v11, v1, 2, 2
    v_lshl_add_u32 v10, v10, 2, v11
    v_lshlrev_b32 v2, 8, v10
    v_lshrrev_b32 v10, 4, v1
    v_lshl_add_u32 v2, v10, 4, v2
    s_sub_u32 s31, s3, 3
    s_mul_i32 s30, s29, 2
    s_add_u32 s30, s30, s31
    s_lshr_b32 s52, s29, 1
    s_lshl_b32 s52, s52, 14
    s_and_b32 s53, s29, 1
    s_lshl_b32 s53, s53, 12
    s_add_u32 s52, s52, s53
    s_mul_i32 s53, s31, 7864320
    s_add_u32 s60, s52, s53
    s_mov_b32 s48, 8192
    s_lshl_b32 s52, s28, 24
    s_waitcnt lgkmcnt(0)
    s_add_u32 s32, s6, s52
    s_addc_u32 s33, s7, 0
    s_mov_b32 s34, 16777216
    s_mov_b32 s35, 0x20000
    s_add_u32 s36, s8, s52
    s_addc_u32 s37, s9, 0
    s_mov_b32 s38, 16777216
    s_mov_b32 s39, 0x20000
    s_and_b32 s59, s28, 1
    s_lshl_b32 s59, s59, 21
    s_barrier
    s_xor_b32 s52, s60, s59
    v_add_u32 v4, s52, v2
    v_add_u32 v5, s52, v3
    buffer_load_dwordx4 v[164:167], v4, s[32:35], 0 offen offset:0 nt
    buffer_load_dwordx4 v[168:171], v4, s[32:35], 0 offen offset:64 nt
    buffer_load_dwordx4 v[172:175], v4, s[32:35], 0 offen offset:128 nt
    buffer_load_dwordx4 v[176:179], v4, s[32:35], 0 offen offset:192 nt
    buffer_load_dwordx4 v[180:183], v4, s[32:35], s48 offen offset:0 nt
    buffer_load_dwordx4 v[184:187], v4, s[32:35], s48 offen offset:64 nt
    buffer_load_dwordx4 v[188:191], v4, s[32:35], s48 offen offset:128 nt
    buffer_load_dwordx4 v[192:195], v4, s[32:35], s48 offen offset:192 nt
    buffer_load_dwordx4 v[196:199], v5, s[36:39], 0 offen offset:0 nt
    buffer_load_dwordx4 v[200:203], v5, s[36:39], 0 offen offset:1024 nt
    buffer_load_dwordx4 v[204:207], v5, s[36:39], 0 offen offset:2048 nt
    buffer_load_dwordx4 v[208:211], v5, s[36:39], 0 offen offset:3072 nt
    buffer_load_dwordx4 v[212:215], v5, s[36:39], s48 offen offset:0 nt
    buffer_load_dwordx4 v[216:219], v5, s[36:39], s48 offen offset:1024 nt
    buffer_load_dwordx4 v[220:223], v5, s[36:39], s48 offen offset:2048 nt
    buffer_load_dwordx4 v[224:227], v5, s[36:39], s48 offen offset:3072 nt
    s_load_dword s77, s[26:27], 32768
    s_mov_b32 s96, 255
    s_not_b32 s97, s96
    s_mov_b32 s40, s26
    s_mov_b32 s41, s27
    s_mov_b32 s42, 2097152
    s_mov_b32 s43, 0x20000
    v_and_b32 v10, 1, v1
    v_lshlrev_b32 v10, 4, v10
    v_mov_b32 v11, 0xffff
    v_lshlrev_b32 v11, v10, v11
    v_bfe_u32 v10, v1, 1, 2
    v_cmp_eq_u32 s[90:91], 0, v10
    v_cmp_eq_u32 s[92:93], 1, v10
    v_cmp_eq_u32 s[94:95], 2, v10
    v_cmp_eq_u32 vcc, 3, v10
    v_cndmask_b32 v14, 0, v11, s[90:91]
    v_cndmask_b32 v15, 0, v11, s[92:93]
    v_cndmask_b32 v16, 0, v11, s[94:95]
    v_cndmask_b32 v17, 0, v11, vcc
    v_mov_b32 v160, v3
    v_lshlrev_b32 v161, 1, v1
    s_mul_i32 s52, s28, 32
    s_add_u32 s52, s52, s30
    s_mul_i32 s52, s52, 1152
    s_add_u32 s61, s52, 1376256
    s_add_u32 s62, s61, 1024
    s_mov_b32 s71, 58
    s_mov_b32 s72, 0
    s_mov_b32 s73, 0
    s_and_b32 s63, s31, 0
    s_lshl_b32 s52, s28, 2
    s_add_u32 s52, s52, s63
    s_lshl_b32 s52, s52, 8
    s_mul_i32 s63, s63, 8192
    s_add_u32 s63, s63, 15728640
    s_add_u32 s74, s26, s52
    s_addc_u32 s75, s27, 0
    s_mov_b32 s66, 0x3db504f3
    s_mov_b32 s67, s66
    s_mov_b32 s68, 0x3fb8aa3b
    s_mov_b32 s69, 0xffff0000
    v_mov_b32 v0, 0
    v_mov_b32 v6, 0xf149f2ca
    v_mov_b32 v7, 0x71800000
    v_mov_b32 v8, 0
    v_mov_b32 v9, 0
    v_mov_b32 v28, 0
    v_mov_b32 v29, 0
    v_mov_b32 v30, 0
    v_mov_b32 v31, 0
    v_bfe_u32 v10, v1, 3, 1
    v_lshlrev_b32 v10, 8, v10
    v_lshrrev_b32 v11, 4, v1
    v_lshl_add_u32 v18, v11, 4, v10
    s_waitcnt lgkmcnt(0)
    s_add_u32 s77, s77, 1
    s_and_b32 s76, s77, s96
    v_mov_b32 v19, s76
    v_mov_b32 v10, 0
    s_mov_b32 s76, 400000
L_lw13:
    ds_read_b32 v11, v10 offset:3076
    s_waitcnt lgkmcnt(0)
    v_cmp_gt_u32 vcc, 1, v11
    s_cbranch_vccz L_lwd14
    s_sub_u32 s76, s76, 1
    s_cbranch_scc1 L_lwd14
    s_sleep 1
    s_branch L_lw13
L_lwd14:
    s_add_u32 s60, s60, 131072
    s_xor_b32 s52, s60, s59
    v_add_u32 v4, s52, v2
    v_add_u32 v5, s52, v3
    buffer_load_dwordx4 v[64:67], v4, s[32:35], 0 offen offset:0 nt
    buffer_load_dwordx4 v[68:71], v4, s[32:35], 0 offen offset:64 nt
    buffer_load_dwordx4 v[72:75], v4, s[32:35], 0 offen offset:128 nt
    buffer_load_dwordx4 v[76:79], v4, s[32:35], 0 offen offset:192 nt
    buffer_load_dwordx4 v[80:83], v4, s[32:35], s48 offen offset:0 nt
    buffer_load_dwordx4 v[84:87], v4, s[32:35], s48 offen offset:64 nt
    buffer_load_dwordx4 v[88:91], v4, s[32:35], s48 offen offset:128 nt
    buffer_load_dwordx4 v[92:95], v4, s[32:35], s48 offen offset:192 nt
    buffer_load_dwordx4 v[96:99], v5, s[36:39], 0 offen offset:0 nt
    buffer_load_dwordx4 v[100:103], v5, s[36:39], 0 offen offset:1024 nt
    buffer_load_dwordx4 v[104:107], v5, s[36:39], 0 offen offset:2048 nt
    buffer_load_dwordx4 v[108:111], v5, s[36:39], 0 offen offset:3072 nt
    buffer_load_dwordx4 v[112:115], v5, s[36:39], s48 offen offset:0 nt
    buffer_load_dwordx4 v[116:119], v5, s[36:39], s48 offen offset:1024 nt
    buffer_load_dwordx4 v[120:123], v5, s[36:39], s48 offen offset:2048 nt
    buffer_load_dwordx4 v[124:127], v5, s[36:39], s48 offen offset:3072 nt
    v_mov_b32 v10, 0
    s_mov_b32 s76, 400000
L_lw15:
    ds_read_b32 v11, v10 offset:3072
    s_waitcnt lgkmcnt(0)
    v_cmp_gt_u32 vcc, 2, v11
    s_cbranch_vccz L_lwd16
    s_sub_u32 s76, s76, 1
    s_cbranch_scc1 L_lwd16
    s_sleep 1
    s_branch L_lw15
L_lwd16:
    ds_read_b128 v[48:51], v18 offset:2304
    ds_read_b128 v[52:55], v18 offset:2368
    ds_read_b128 v[56:59], v18 offset:2432
    ds_read_b128 v[60:63], v18 offset:2496
    s_waitcnt lgkmcnt(0)
    s_waitcnt vmcnt(28)
    v_mfma_f32_16x16x32_bf16 v[20:23], v[164:167], v[48:51], 0
    v_mfma_f32_16x16x32_bf16 v[20:23], v[168:171], v[52:55], v[20:23]
    v_mfma_f32_16x16x32_bf16 v[20:23], v[172:175], v[56:59], v[20:23]
    v_mfma_f32_16x16x32_bf16 v[20:23], v[176:179], v[60:63], v[20:23]
    s_waitcnt vmcnt(24)
    v_mfma_f32_16x16x32_bf16 v[128:131], v[180:183], v[48:51], 0
    v_mfma_f32_16x16x32_bf16 v[128:131], v[184:187], v[52:55], v[128:131]
    v_mfma_f32_16x16x32_bf16 v[128:131], v[188:191], v[56:59], v[128:131]
    v_mfma_f32_16x16x32_bf16 v[128:131], v[192:195], v[60:63], v[128:131]
    s_nop 2
    v_cvt_pk_bf16_f32 v12, v20, v21
    v_cvt_pk_bf16_f32 v13, v22, v23
    v_lshlrev_b32 v24, 16, v12
    v_and_b32 v25, s69, v12
    v_lshlrev_b32 v26, 16, v13
    v_and_b32 v27, s69, v13
    v_pk_mul_f32 v[24:25], v[24:25], s[66:67]
    v_pk_mul_f32 v[26:27], v[26:27], s[66:67]
    v_cvt_pk_bf16_f32 v12, v24, v25
    v_cvt_pk_bf16_f32 v13, v26, v27
    v_lshlrev_b32 v24, 16, v12
    v_and_b32 v25, s69, v12
    v_lshlrev_b32 v26, 16, v13
    v_and_b32 v27, s69, v13
    v_max3_f32 v10, v24, v25, v26
    v_max_f32 v10, v10, v27
    v_cvt_pk_bf16_f32 v12, v128, v129
    v_cvt_pk_bf16_f32 v13, v130, v131
    v_lshlrev_b32 v132, 16, v12
    v_and_b32 v133, s69, v12
    v_lshlrev_b32 v134, 16, v13
    v_and_b32 v135, s69, v13
    v_pk_mul_f32 v[132:133], v[132:133], s[66:67]
    v_pk_mul_f32 v[134:135], v[134:135], s[66:67]
    v_cvt_pk_bf16_f32 v12, v132, v133
    v_cvt_pk_bf16_f32 v13, v134, v135
    v_lshlrev_b32 v132, 16, v12
    v_and_b32 v133, s69, v12
    v_lshlrev_b32 v134, 16, v13
    v_and_b32 v135, s69, v13
    v_max3_f32 v10, v10, v132, v133
    v_max3_f32 v10, v10, v134, v135
    v_cmp_gt_f32 vcc, v10, v6
    s_cbranch_vccnz L_rarex
L_backx:
    v_fma_f32 v24, v24, s68, v7
    v_fma_f32 v25, v25, s68, v7
    v_fma_f32 v26, v26, s68, v7
    v_fma_f32 v27, v27, s68, v7
    v_exp_f32 v24, v24
    v_exp_f32 v25, v25
    v_exp_f32 v26, v26
    v_exp_f32 v27, v27
    v_cvt_pk_bf16_f32 v20, v24, v24
    v_cvt_pk_bf16_f32 v21, v25, v25
    v_pk_add_f32 v[8:9], v[8:9], v[24:25]
    v_cvt_pk_bf16_f32 v22, v26, v26
    v_cvt_pk_bf16_f32 v23, v27, v27
    v_pk_add_f32 v[8:9], v[8:9], v[26:27]
    v_and_b32 v32, v20, v14
    v_and_b32 v33, v20, v15
    v_and_b32 v34, v20, v16
    v_and_b32 v35, v20, v17
    v_and_b32 v36, v21, v14
    v_and_b32 v37, v21, v15
    v_and_b32 v38, v21, v16
    v_and_b32 v39, v21, v17
    v_and_b32 v40, v22, v14
    v_and_b32 v41, v22, v15
    v_and_b32 v42, v22, v16
    v_and_b32 v43, v22, v17
    v_and_b32 v44, v23, v14
    v_and_b32 v45, v23, v15
    v_and_b32 v46, v23, v16
    v_and_b32 v47, v23, v17
    v_fma_f32 v132, v132, s68, v7
    v_fma_f32 v133, v133, s68, v7
    v_fma_f32 v134, v134, s68, v7
    v_fma_f32 v135, v135, s68, v7
    v_exp_f32 v132, v132
    v_exp_f32 v133, v133
    v_exp_f32 v134, v134
    v_exp_f32 v135, v135
    v_cvt_pk_bf16_f32 v128, v132, v132
    v_cvt_pk_bf16_f32 v129, v133, v133
    v_pk_add_f32 v[8:9], v[8:9], v[132:133]
    v_cvt_pk_bf16_f32 v130, v134, v134
    v_cvt_pk_bf16_f32 v131, v135, v135
    v_pk_add_f32 v[8:9], v[8:9], v[134:135]
    v_and_b32 v136, v128, v14
    v_and_b32 v137, v128, v15
    v_and_b32 v138, v128, v16
    v_and_b32 v139, v128, v17
    v_and_b32 v140, v129, v14
    v_and_b32 v141, v129, v15
    v_and_b32 v142, v129, v16
    v_and_b32 v143, v129, v17
    v_and_b32 v144, v130, v14
    v_and_b32 v145, v130, v15
    v_and_b32 v146, v130, v16
    v_and_b32 v147, v130, v17
    v_and_b32 v148, v131, v14
    v_and_b32 v149, v131, v15
    v_and_b32 v150, v131, v16
    v_and_b32 v151, v131, v17
    s_waitcnt vmcnt(20)
    v_mfma_f32_16x16x32_bf16 v[28:31], v[196:199], v[32:35], v[28:31]
    v_mfma_f32_16x16x32_bf16 v[28:31], v[200:203], v[36:39], v[28:31]
    v_mfma_f32_16x16x32_bf16 v[28:31], v[204:207], v[40:43], v[28:31]
    v_mfma_f32_16x16x32_bf16 v[28:31], v[208:211], v[44:47], v[28:31]
    s_waitcnt vmcnt(16)
    v_mfma_f32_16x16x32_bf16 v[28:31], v[212:215], v[136:139], v[28:31]
    v_mfma_f32_16x16x32_bf16 v[28:31], v[216:219], v[140:143], v[28:31]
    v_mfma_f32_16x16x32_bf16 v[28:31], v[220:223], v[144:147], v[28:31]
    v_mfma_f32_16x16x32_bf16 v[28:31], v[224:227], v[148:151], v[28:31]
.p2align 6
L_loop:
    s_waitcnt vmcnt(12)
    v_mfma_f32_16x16x32_bf16 v[20:23], v[64:67], v[48:51], 0
    v_mfma_f32_16x16x32_bf16 v[20:23], v[68:71], v[52:55], v[20:23]
    v_mfma_f32_16x16x32_bf16 v[20:23], v[72:75], v[56:59], v[20:23]
    v_mfma_f32_16x16x32_bf16 v[20:23], v[76:79], v[60:63], v[20:23]
    s_waitcnt vmcnt(8)
    v_mfma_f32_16x16x32_bf16 v[128:131], v[80:83], v[48:51], 0
    v_mfma_f32_16x16x32_bf16 v[128:131], v[84:87], v[52:55], v[128:131]
    v_mfma_f32_16x16x32_bf16 v[128:131], v[88:91], v[56:59], v[128:131]
    v_mfma_f32_16x16x32_bf16 v[128:131], v[92:95], v[60:63], v[128:131]
    s_cmp_eq_u32 s71, 0
    s_cbranch_scc1 L_tick
    s_add_u32 s60, s60, 131072
    s_sub_u32 s71, s71, 1
    s_cmp_lg_u32 s71, 0
    s_cbranch_scc1 L_next
L_ask:
    s_mov_b32 s72, 1
    s_atomic_add s72, s[74:75], 0x0 glc
L_next:
    s_xor_b32 s52, s60, s59
    v_add_u32 v4, s52, v2
    v_add_u32 v5, s52, v3
    buffer_load_dwordx4 v[64:67], v4, s[32:35], 0 offen offset:0 nt
    buffer_load_dwordx4 v[68:71], v4, s[32:35], 0 offen offset:64 nt
    buffer_load_dwordx4 v[72:75], v4, s[32:35], 0 offen offset:128 nt
    buffer_load_dwordx4 v[76:79], v4, s[32:35], 0 offen offset:192 nt
    buffer_load_dwordx4 v[80:83], v4, s[32:35], s48 offen offset:0 nt
    buffer_load_dwordx4 v[84:87], v4, s[32:35], s48 offen offset:64 nt
    buffer_load_dwordx4 v[88:91], v4, s[32:35], s48 offen offset:128 nt
    buffer_load_dwordx4 v[92:95], v4, s[32:35], s48 offen offset:192 nt
    v_cvt_pk_bf16_f32 v12, v20, v21
    v_cvt_pk_bf16_f32 v13, v22, v23
    v_lshlrev_b32 v24, 16, v12
    v_and_b32 v25, s69, v12
    v_lshlrev_b32 v26, 16, v13
    v_and_b32 v27, s69, v13
    v_pk_mul_f32 v[24:25], v[24:25], s[66:67]
    v_pk_mul_f32 v[26:27], v[26:27], s[66:67]
    v_cvt_pk_bf16_f32 v12, v24, v25
    v_cvt_pk_bf16_f32 v13, v26, v27
    v_lshlrev_b32 v24, 16, v12
    v_and_b32 v25, s69, v12
    v_lshlrev_b32 v26, 16, v13
    v_and_b32 v27, s69, v13
    v_max3_f32 v10, v24, v25, v26
    v_max_f32 v10, v10, v27
    v_cvt_pk_bf16_f32 v12, v128, v129
    v_cvt_pk_bf16_f32 v13, v130, v131
    v_lshlrev_b32 v132, 16, v12
    v_and_b32 v133, s69, v12
    v_lshlrev_b32 v134, 16, v13
    v_and_b32 v135, s69, v13
    v_pk_mul_f32 v[132:133], v[132:133], s[66:67]
    v_pk_mul_f32 v[134:135], v[134:135], s[66:67]
    v_cvt_pk_bf16_f32 v12, v132, v133
    v_cvt_pk_bf16_f32 v13, v134, v135
    v_lshlrev_b32 v132, 16, v12
    v_and_b32 v133, s69, v12
    v_lshlrev_b32 v134, 16, v13
    v_and_b32 v135, s69, v13
    v_max3_f32 v10, v10, v132, v133
    v_max3_f32 v10, v10, v134, v135
    v_cmp_gt_f32 vcc, v10, v6
    s_cbranch_vccnz L_rarem
L_backm:
    v_fma_f32 v24, v24, s68, v7
    v_fma_f32 v25, v25, s68, v7
    v_fma_f32 v26, v26, s68, v7
    v_fma_f32 v27, v27, s68, v7
    v_exp_f32 v24, v24
    v_exp_f32 v25, v25
    v_exp_f32 v26, v26
    v_exp_f32 v27, v27
    v_cvt_pk_bf16_f32 v20, v24, v24
    v_cvt_pk_bf16_f32 v21, v25, v25
    v_pk_add_f32 v[8:9], v[8:9], v[24:25]
    v_cvt_pk_bf16_f32 v22, v26, v26
    v_cvt_pk_bf16_f32 v23, v27, v27
    v_pk_add_f32 v[8:9], v[8:9], v[26:27]
    v_and_b32 v32, v20, v14
    v_and_b32 v33, v20, v15
    v_and_b32 v34, v20, v16
    v_and_b32 v35, v20, v17
    v_and_b32 v36, v21, v14
    v_and_b32 v37, v21, v15
    v_and_b32 v38, v21, v16
    v_and_b32 v39, v21, v17
    v_and_b32 v40, v22, v14
    v_and_b32 v41, v22, v15
    v_and_b32 v42, v22, v16
    v_and_b32 v43, v22, v17
    v_and_b32 v44, v23, v14
    v_and_b32 v45, v23, v15
    v_and_b32 v46, v23, v16
    v_and_b32 v47, v23, v17
    v_fma_f32 v132, v132, s68, v7
    v_fma_f32 v133, v133, s68, v7
    v_fma_f32 v134, v134, s68, v7
    v_fma_f32 v135, v135, s68, v7
    v_exp_f32 v132, v132
    v_exp_f32 v133, v133
    v_exp_f32 v134, v134
    v_exp_f32 v135, v135
    v_cvt_pk_bf16_f32 v128, v132, v132
    v_cvt_pk_bf16_f32 v129, v133, v133
    v_pk_add_f32 v[8:9], v[8:9], v[132:133]
    v_cvt_pk_bf16_f32 v130, v134, v134
    v_cvt_pk_bf16_f32 v131, v135, v135
    v_pk_add_f32 v[8:9], v[8:9], v[134:135]
    v_and_b32 v136, v128, v14
    v_and_b32 v137, v128, v15
    v_and_b32 v138, v128, v16
    v_and_b32 v139, v128, v17
    v_and_b32 v140, v129, v14
    v_and_b32 v141, v129, v15
    v_and_b32 v142, v129, v16
    v_and_b32 v143, v129, v17
    v_and_b32 v144, v130, v14
    v_and_b32 v145, v130, v15
    v_and_b32 v146, v130, v16
    v_and_b32 v147, v130, v17
    v_and_b32 v148, v131, v14
    v_and_b32 v149, v131, v15
    v_and_b32 v150, v131, v16
    v_and_b32 v151, v131, v17
    s_waitcnt vmcnt(12)
    v_mfma_f32_16x16x32_bf16 v[28:31], v[96:99], v[32:35], v[28:31]
    v_mfma_f32_16x16x32_bf16 v[28:31], v[100:103], v[36:39], v[28:31]
    v_mfma_f32_16x16x32_bf16 v[28:31], v[104:107], v[40:43], v[28:31]
    v_mfma_f32_16x16x32_bf16 v[28:31], v[108:111], v[44:47], v[28:31]
    s_waitcnt vmcnt(8)
    v_mfma_f32_16x16x32_bf16 v[28:31], v[112:115], v[136:139], v[28:31]
    v_mfma_f32_16x16x32_bf16 v[28:31], v[116:119], v[140:143], v[28:31]
    v_mfma_f32_16x16x32_bf16 v[28:31], v[120:123], v[144:147], v[28:31]
    v_mfma_f32_16x16x32_bf16 v[28:31], v[124:127], v[148:151], v[28:31]
    buffer_load_dwordx4 v[96:99], v5, s[36:39], 0 offen offset:0 nt
    buffer_load_dwordx4 v[100:103], v5, s[36:39], 0 offen offset:1024 nt
    buffer_load_dwordx4 v[104:107], v5, s[36:39], 0 offen offset:2048 nt
    buffer_load_dwordx4 v[108:111], v5, s[36:39], 0 offen offset:3072 nt
    buffer_load_dwordx4 v[112:115], v5, s[36:39], s48 offen offset:0 nt
    buffer_load_dwordx4 v[116:119], v5, s[36:39], s48 offen offset:1024 nt
    buffer_load_dwordx4 v[120:123], v5, s[36:39], s48 offen offset:2048 nt
    buffer_load_dwordx4 v[124:127], v5, s[36:39], s48 offen offset:3072 nt
    s_branch L_loop
L_tick:
    s_waitcnt lgkmcnt(0)
    s_lshr_b32 s52, s72, 1
    s_lshl_b32 s52, s52, 14
    s_and_b32 s53, s72, 1
    s_lshl_b32 s53, s53, 12
    s_add_u32 s52, s52, s53
    s_add_u32 s60, s52, 15728640
    s_cmp_lt_u32 s60, 16646144
    s_cbranch_scc1 L_ask
    s_cmp_ge_u32 s60, 16777216
    s_cbranch_scc1 L_last
    s_xor_b32 s52, s60, s59
    v_add_u32 v4, s52, v2
    v_add_u32 v5, s52, v3
    buffer_load_dwordx4 v[164:167], v4, s[32:35], 0 offen offset:0 nt
    buffer_load_dwordx4 v[168:171], v4, s[32:35], 0 offen offset:64 nt
    buffer_load_dwordx4 v[172:175], v4, s[32:35], 0 offen offset:128 nt
    buffer_load_dwordx4 v[176:179], v4, s[32:35], 0 offen offset:192 nt
    buffer_load_dwordx4 v[180:183], v4, s[32:35], s48 offen offset:0 nt
    buffer_load_dwordx4 v[184:187], v4, s[32:35], s48 offen offset:64 nt
    buffer_load_dwordx4 v[188:191], v4, s[32:35], s48 offen offset:128 nt
    buffer_load_dwordx4 v[192:195], v4, s[32:35], s48 offen offset:192 nt
    buffer_load_dwordx4 v[196:199], v5, s[36:39], 0 offen offset:0 nt
    buffer_load_dwordx4 v[200:203], v5, s[36:39], 0 offen offset:1024 nt
    buffer_load_dwordx4 v[204:207], v5, s[36:39], 0 offen offset:2048 nt
    buffer_load_dwordx4 v[208:211], v5, s[36:39], 0 offen offset:3072 nt
    buffer_load_dwordx4 v[212:215], v5, s[36:39], s48 offen offset:0 nt
    buffer_load_dwordx4 v[216:219], v5, s[36:39], s48 offen offset:1024 nt
    buffer_load_dwordx4 v[220:223], v5, s[36:39], s48 offen offset:2048 nt
    buffer_load_dwordx4 v[224:227], v5, s[36:39], s48 offen offset:3072 nt
    v_cvt_pk_bf16_f32 v12, v20, v21
    v_cvt_pk_bf16_f32 v13, v22, v23
    v_lshlrev_b32 v24, 16, v12
    v_and_b32 v25, s69, v12
    v_lshlrev_b32 v26, 16, v13
    v_and_b32 v27, s69, v13
    v_pk_mul_f32 v[24:25], v[24:25], s[66:67]
    v_pk_mul_f32 v[26:27], v[26:27], s[66:67]
    v_cvt_pk_bf16_f32 v12, v24, v25
    v_cvt_pk_bf16_f32 v13, v26, v27
    v_lshlrev_b32 v24, 16, v12
    v_and_b32 v25, s69, v12
    v_lshlrev_b32 v26, 16, v13
    v_and_b32 v27, s69, v13
    v_max3_f32 v10, v24, v25, v26
    v_max_f32 v10, v10, v27
    v_cvt_pk_bf16_f32 v12, v128, v129
    v_cvt_pk_bf16_f32 v13, v130, v131
    v_lshlrev_b32 v132, 16, v12
    v_and_b32 v133, s69, v12
    v_lshlrev_b32 v134, 16, v13
    v_and_b32 v135, s69, v13
    v_pk_mul_f32 v[132:133], v[132:133], s[66:67]
    v_pk_mul_f32 v[134:135], v[134:135], s[66:67]
    v_cvt_pk_bf16_f32 v12, v132, v133
    v_cvt_pk_bf16_f32 v13, v134, v135
    v_lshlrev_b32 v132, 16, v12
    v_and_b32 v133, s69, v12
    v_lshlrev_b32 v134, 16, v13
    v_and_b32 v135, s69, v13
    v_max3_f32 v10, v10, v132, v133
    v_max3_f32 v10, v10, v134, v135
    v_cmp_gt_f32 vcc, v10, v6
    s_cbranch_vccnz L_raref
L_backf:
    v_fma_f32 v24, v24, s68, v7
    v_fma_f32 v25, v25, s68, v7
    v_fma_f32 v26, v26, s68, v7
    v_fma_f32 v27, v27, s68, v7
    v_exp_f32 v24, v24
    v_exp_f32 v25, v25
    v_exp_f32 v26, v26
    v_exp_f32 v27, v27
    v_cvt_pk_bf16_f32 v20, v24, v24
    v_cvt_pk_bf16_f32 v21, v25, v25
    v_pk_add_f32 v[8:9], v[8:9], v[24:25]
    v_cvt_pk_bf16_f32 v22, v26, v26
    v_cvt_pk_bf16_f32 v23, v27, v27
    v_pk_add_f32 v[8:9], v[8:9], v[26:27]
    v_and_b32 v32, v20, v14
    v_and_b32 v33, v20, v15
    v_and_b32 v34, v20, v16
    v_and_b32 v35, v20, v17
    v_and_b32 v36, v21, v14
    v_and_b32 v37, v21, v15
    v_and_b32 v38, v21, v16
    v_and_b32 v39, v21, v17
    v_and_b32 v40, v22, v14
    v_and_b32 v41, v22, v15
    v_and_b32 v42, v22, v16
    v_and_b32 v43, v22, v17
    v_and_b32 v44, v23, v14
    v_and_b32 v45, v23, v15
    v_and_b32 v46, v23, v16
    v_and_b32 v47, v23, v17
    v_fma_f32 v132, v132, s68, v7
    v_fma_f32 v133, v133, s68, v7
    v_fma_f32 v134, v134, s68, v7
    v_fma_f32 v135, v135, s68, v7
    v_exp_f32 v132, v132
    v_exp_f32 v133, v133
    v_exp_f32 v134, v134
    v_exp_f32 v135, v135
    v_cvt_pk_bf16_f32 v128, v132, v132
    v_cvt_pk_bf16_f32 v129, v133, v133
    v_pk_add_f32 v[8:9], v[8:9], v[132:133]
    v_cvt_pk_bf16_f32 v130, v134, v134
    v_cvt_pk_bf16_f32 v131, v135, v135
    v_pk_add_f32 v[8:9], v[8:9], v[134:135]
    v_and_b32 v136, v128, v14
    v_and_b32 v137, v128, v15
    v_and_b32 v138, v128, v16
    v_and_b32 v139, v128, v17
    v_and_b32 v140, v129, v14
    v_and_b32 v141, v129, v15
    v_and_b32 v142, v129, v16
    v_and_b32 v143, v129, v17
    v_and_b32 v144, v130, v14
    v_and_b32 v145, v130, v15
    v_and_b32 v146, v130, v16
    v_and_b32 v147, v130, v17
    v_and_b32 v148, v131, v14
    v_and_b32 v149, v131, v15
    v_and_b32 v150, v131, v16
    v_and_b32 v151, v131, v17
    s_waitcnt vmcnt(20)
    v_mfma_f32_16x16x32_bf16 v[28:31], v[96:99], v[32:35], v[28:31]
    v_mfma_f32_16x16x32_bf16 v[28:31], v[100:103], v[36:39], v[28:31]
    v_mfma_f32_16x16x32_bf16 v[28:31], v[104:107], v[40:43], v[28:31]
    v_mfma_f32_16x16x32_bf16 v[28:31], v[108:111], v[44:47], v[28:31]
    s_waitcnt vmcnt(16)
    v_mfma_f32_16x16x32_bf16 v[28:31], v[112:115], v[136:139], v[28:31]
    v_mfma_f32_16x16x32_bf16 v[28:31], v[116:119], v[140:143], v[28:31]
    v_mfma_f32_16x16x32_bf16 v[28:31], v[120:123], v[144:147], v[28:31]
    v_mfma_f32_16x16x32_bf16 v[28:31], v[124:127], v[148:151], v[28:31]
    s_waitcnt vmcnt(12)
    v_mfma_f32_16x16x32_bf16 v[20:23], v[164:167], v[48:51], 0
    v_mfma_f32_16x16x32_bf16 v[20:23], v[168:171], v[52:55], v[20:23]
    v_mfma_f32_16x16x32_bf16 v[20:23], v[172:175], v[56:59], v[20:23]
    v_mfma_f32_16x16x32_bf16 v[20:23], v[176:179], v[60:63], v[20:23]
    s_waitcnt vmcnt(8)
    v_mfma_f32_16x16x32_bf16 v[128:131], v[180:183], v[48:51], 0
    v_mfma_f32_16x16x32_bf16 v[128:131], v[184:187], v[52:55], v[128:131]
    v_mfma_f32_16x16x32_bf16 v[128:131], v[188:191], v[56:59], v[128:131]
    v_mfma_f32_16x16x32_bf16 v[128:131], v[192:195], v[60:63], v[128:131]
    s_nop 2
    v_cvt_pk_bf16_f32 v12, v20, v21
    v_cvt_pk_bf16_f32 v13, v22, v23
    v_lshlrev_b32 v24, 16, v12
    v_and_b32 v25, s69, v12
    v_lshlrev_b32 v26, 16, v13
    v_and_b32 v27, s69, v13
    v_pk_mul_f32 v[24:25], v[24:25], s[66:67]
    v_pk_mul_f32 v[26:27], v[26:27], s[66:67]
    v_cvt_pk_bf16_f32 v12, v24, v25
    v_cvt_pk_bf16_f32 v13, v26, v27
    v_lshlrev_b32 v24, 16, v12
    v_and_b32 v25, s69, v12
    v_lshlrev_b32 v26, 16, v13
    v_and_b32 v27, s69, v13
    v_max3_f32 v10, v24, v25, v26
    v_max_f32 v10, v10, v27
    v_cvt_pk_bf16_f32 v12, v128, v129
    v_cvt_pk_bf16_f32 v13, v130, v131
    v_lshlrev_b32 v132, 16, v12
    v_and_b32 v133, s69, v12
    v_lshlrev_b32 v134, 16, v13
    v_and_b32 v135, s69, v13
    v_pk_mul_f32 v[132:133], v[132:133], s[66:67]
    v_pk_mul_f32 v[134:135], v[134:135], s[66:67]
    v_cvt_pk_bf16_f32 v12, v132, v133
    v_cvt_pk_bf16_f32 v13, v134, v135
    v_lshlrev_b32 v132, 16, v12
    v_and_b32 v133, s69, v12
    v_lshlrev_b32 v134, 16, v13
    v_and_b32 v135, s69, v13
    v_max3_f32 v10, v10, v132, v133
    v_max3_f32 v10, v10, v134, v135
    v_cmp_gt_f32 vcc, v10, v6
    s_cbranch_vccnz L_rareg
L_backg:
    v_fma_f32 v24, v24, s68, v7
    v_fma_f32 v25, v25, s68, v7
    v_fma_f32 v26, v26, s68, v7
    v_fma_f32 v27, v27, s68, v7
    v_exp_f32 v24, v24
    v_exp_f32 v25, v25
    v_exp_f32 v26, v26
    v_exp_f32 v27, v27
    v_cvt_pk_bf16_f32 v20, v24, v24
    v_cvt_pk_bf16_f32 v21, v25, v25
    v_pk_add_f32 v[8:9], v[8:9], v[24:25]
    v_cvt_pk_bf16_f32 v22, v26, v26
    v_cvt_pk_bf16_f32 v23, v27, v27
    v_pk_add_f32 v[8:9], v[8:9], v[26:27]
    v_and_b32 v32, v20, v14
    v_and_b32 v33, v20, v15
    v_and_b32 v34, v20, v16
    v_and_b32 v35, v20, v17
    v_and_b32 v36, v21, v14
    v_and_b32 v37, v21, v15
    v_and_b32 v38, v21, v16
    v_and_b32 v39, v21, v17
    v_and_b32 v40, v22, v14
    v_and_b32 v41, v22, v15
    v_and_b32 v42, v22, v16
    v_and_b32 v43, v22, v17
    v_and_b32 v44, v23, v14
    v_and_b32 v45, v23, v15
    v_and_b32 v46, v23, v16
    v_and_b32 v47, v23, v17
    v_fma_f32 v132, v132, s68, v7
    v_fma_f32 v133, v133, s68, v7
    v_fma_f32 v134, v134, s68, v7
    v_fma_f32 v135, v135, s68, v7
    v_exp_f32 v132, v132
    v_exp_f32 v133, v133
    v_exp_f32 v134, v134
    v_exp_f32 v135, v135
    v_cvt_pk_bf16_f32 v128, v132, v132
    v_cvt_pk_bf16_f32 v129, v133, v133
    v_pk_add_f32 v[8:9], v[8:9], v[132:133]
    v_cvt_pk_bf16_f32 v130, v134, v134
    v_cvt_pk_bf16_f32 v131, v135, v135
    v_pk_add_f32 v[8:9], v[8:9], v[134:135]
    v_and_b32 v136, v128, v14
    v_and_b32 v137, v128, v15
    v_and_b32 v138, v128, v16
    v_and_b32 v139, v128, v17
    v_and_b32 v140, v129, v14
    v_and_b32 v141, v129, v15
    v_and_b32 v142, v129, v16
    v_and_b32 v143, v129, v17
    v_and_b32 v144, v130, v14
    v_and_b32 v145, v130, v15
    v_and_b32 v146, v130, v16
    v_and_b32 v147, v130, v17
    v_and_b32 v148, v131, v14
    v_and_b32 v149, v131, v15
    v_and_b32 v150, v131, v16
    v_and_b32 v151, v131, v17
    v_add_f32 v9, v8, v9
    v_sub_f32 v8, 0, v7
    v_mov_b32 v11, v9
    s_nop 1
    v_permlane16_swap_b32 v9, v11
    v_add_f32 v9, v9, v11
    v_mov_b32 v11, v9
    s_nop 1
    v_permlane32_swap_b32 v9, v11
    v_add_f32 v9, v9, v11
    v_and_or_b32 v8, v8, s97, v19
    v_and_or_b32 v9, v9, s97, v19
    v_mov_b32 v10, v8
    v_mov_b32 v11, v9
    s_mov_b64 exec, 257
    buffer_store_dwordx4 v[8:11], v161, s[40:43], s62 offen sc1
    s_mov_b64 exec, -1
    s_waitcnt vmcnt(5)
    v_mfma_f32_16x16x32_bf16 v[28:31], v[196:199], v[32:35], v[28:31]
    v_mfma_f32_16x16x32_bf16 v[28:31], v[200:203], v[36:39], v[28:31]
    v_mfma_f32_16x16x32_bf16 v[28:31], v[204:207], v[40:43], v[28:31]
    v_mfma_f32_16x16x32_bf16 v[28:31], v[208:211], v[44:47], v[28:31]
    s_waitcnt vmcnt(1)
    v_mfma_f32_16x16x32_bf16 v[28:31], v[212:215], v[136:139], v[28:31]
    v_mfma_f32_16x16x32_bf16 v[28:31], v[216:219], v[140:143], v[28:31]
    v_mfma_f32_16x16x32_bf16 v[28:31], v[220:223], v[144:147], v[28:31]
    v_mfma_f32_16x16x32_bf16 v[28:31], v[224:227], v[148:151], v[28:31]
    s_nop 7
    v_and_or_b32 v28, v28, s97, v19
    v_and_or_b32 v29, v29, s97, v19
    v_and_or_b32 v30, v30, s97, v19
    v_and_or_b32 v31, v31, s97, v19
    buffer_store_dwordx4 v[28:31], v160, s[40:43], s61 offen sc1
    s_barrier
    s_endpgm
L_last:
    v_cvt_pk_bf16_f32 v12, v20, v21
    v_cvt_pk_bf16_f32 v13, v22, v23
    v_lshlrev_b32 v24, 16, v12
    v_and_b32 v25, s69, v12
    v_lshlrev_b32 v26, 16, v13
    v_and_b32 v27, s69, v13
    v_pk_mul_f32 v[24:25], v[24:25], s[66:67]
    v_pk_mul_f32 v[26:27], v[26:27], s[66:67]
    v_cvt_pk_bf16_f32 v12, v24, v25
    v_cvt_pk_bf16_f32 v13, v26, v27
    v_lshlrev_b32 v24, 16, v12
    v_and_b32 v25, s69, v12
    v_lshlrev_b32 v26, 16, v13
    v_and_b32 v27, s69, v13
    v_max3_f32 v10, v24, v25, v26
    v_max_f32 v10, v10, v27
    v_cvt_pk_bf16_f32 v12, v128, v129
    v_cvt_pk_bf16_f32 v13, v130, v131
    v_lshlrev_b32 v132, 16, v12
    v_and_b32 v133, s69, v12
    v_lshlrev_b32 v134, 16, v13
    v_and_b32 v135, s69, v13
    v_pk_mul_f32 v[132:133], v[132:133], s[66:67]
    v_pk_mul_f32 v[134:135], v[134:135], s[66:67]
    v_cvt_pk_bf16_f32 v12, v132, v133
    v_cvt_pk_bf16_f32 v13, v134, v135
    v_lshlrev_b32 v132, 16, v12
    v_and_b32 v133, s69, v12
    v_lshlrev_b32 v134, 16, v13
    v_and_b32 v135, s69, v13
    v_max3_f32 v10, v10, v132, v133
    v_max3_f32 v10, v10, v134, v135
    v_cmp_gt_f32 vcc, v10, v6
    s_cbranch_vccnz L_rarel
L_backl:
    v_fma_f32 v24, v24, s68, v7
    v_fma_f32 v25, v25, s68, v7
    v_fma_f32 v26, v26, s68, v7
    v_fma_f32 v27, v27, s68, v7
    v_exp_f32 v24, v24
    v_exp_f32 v25, v25
    v_exp_f32 v26, v26
    v_exp_f32 v27, v27
    v_cvt_pk_bf16_f32 v20, v24, v24
    v_cvt_pk_bf16_f32 v21, v25, v25
    v_pk_add_f32 v[8:9], v[8:9], v[24:25]
    v_cvt_pk_bf16_f32 v22, v26, v26
    v_cvt_pk_bf16_f32 v23, v27, v27
    v_pk_add_f32 v[8:9], v[8:9], v[26:27]
    v_and_b32 v32, v20, v14
    v_and_b32 v33, v20, v15
    v_and_b32 v34, v20, v16
    v_and_b32 v35, v20, v17
    v_and_b32 v36, v21, v14
    v_and_b32 v37, v21, v15
    v_and_b32 v38, v21, v16
    v_and_b32 v39, v21, v17
    v_and_b32 v40, v22, v14
    v_and_b32 v41, v22, v15
    v_and_b32 v42, v22, v16
    v_and_b32 v43, v22, v17
    v_and_b32 v44, v23, v14
    v_and_b32 v45, v23, v15
    v_and_b32 v46, v23, v16
    v_and_b32 v47, v23, v17
    v_fma_f32 v132, v132, s68, v7
    v_fma_f32 v133, v133, s68, v7
    v_fma_f32 v134, v134, s68, v7
    v_fma_f32 v135, v135, s68, v7
    v_exp_f32 v132, v132
    v_exp_f32 v133, v133
    v_exp_f32 v134, v134
    v_exp_f32 v135, v135
    v_cvt_pk_bf16_f32 v128, v132, v132
    v_cvt_pk_bf16_f32 v129, v133, v133
    v_pk_add_f32 v[8:9], v[8:9], v[132:133]
    v_cvt_pk_bf16_f32 v130, v134, v134
    v_cvt_pk_bf16_f32 v131, v135, v135
    v_pk_add_f32 v[8:9], v[8:9], v[134:135]
    v_and_b32 v136, v128, v14
    v_and_b32 v137, v128, v15
    v_and_b32 v138, v128, v16
    v_and_b32 v139, v128, v17
    v_and_b32 v140, v129, v14
    v_and_b32 v141, v129, v15
    v_and_b32 v142, v129, v16
    v_and_b32 v143, v129, v17
    v_and_b32 v144, v130, v14
    v_and_b32 v145, v130, v15
    v_and_b32 v146, v130, v16
    v_and_b32 v147, v130, v17
    v_and_b32 v148, v131, v14
    v_and_b32 v149, v131, v15
    v_and_b32 v150, v131, v16
    v_and_b32 v151, v131, v17
    v_add_f32 v9, v8, v9
    v_sub_f32 v8, 0, v7
    v_mov_b32 v11, v9
    s_nop 1
    v_permlane16_swap_b32 v9, v11
    v_add_f32 v9, v9, v11
    v_mov_b32 v11, v9
    s_nop 1
    v_permlane32_swap_b32 v9, v11
    v_add_f32 v9, v9, v11
    v_and_or_b32 v8, v8, s97, v19
    v_and_or_b32 v9, v9, s97, v19
    v_mov_b32 v10, v8
    v_mov_b32 v11, v9
    s_mov_b64 exec, 257
    buffer_store_dwordx4 v[8:11], v161, s[40:43], s62 offen sc1
    s_mov_b64 exec, -1
    s_waitcnt vmcnt(5)
    v_mfma_f32_16x16x32_bf16 v[28:31], v[96:99], v[32:35], v[28:31]
    v_mfma_f32_16x16x32_bf16 v[28:31], v[100:103], v[36:39], v[28:31]
    v_mfma_f32_16x16x32_bf16 v[28:31], v[104:107], v[40:43], v[28:31]
    v_mfma_f32_16x16x32_bf16 v[28:31], v[108:111], v[44:47], v[28:31]
    s_waitcnt vmcnt(1)
    v_mfma_f32_16x16x32_bf16 v[28:31], v[112:115], v[136:139], v[28:31]
    v_mfma_f32_16x16x32_bf16 v[28:31], v[116:119], v[140:143], v[28:31]
    v_mfma_f32_16x16x32_bf16 v[28:31], v[120:123], v[144:147], v[28:31]
    v_mfma_f32_16x16x32_bf16 v[28:31], v[124:127], v[148:151], v[28:31]
    s_nop 7
    v_and_or_b32 v28, v28, s97, v19
    v_and_or_b32 v29, v29, s97, v19
    v_and_or_b32 v30, v30, s97, v19
    v_and_or_b32 v31, v31, s97, v19
    buffer_store_dwordx4 v[28:31], v160, s[40:43], s61 offen sc1
    s_barrier
    s_endpgm
L_rarex:
    v_mov_b32 v11, v10
    s_nop 1
    v_permlane16_swap_b32 v10, v11
    v_max_f32 v10, v10, v11
    v_mov_b32 v11, v10
    s_nop 1
    v_permlane32_swap_b32 v10, v11
    v_max3_f32 v6, v10, v11, v6
    v_mul_f32 v11, s68, v6
    v_and_b32 v11, s97, v11
    v_add_f32 v10, v7, v11
    v_exp_f32 v10, -v10
    v_sub_f32 v7, 0, v11
    v_mul_f32 v28, v28, v10
    v_mul_f32 v29, v29, v10
    v_mul_f32 v30, v30, v10
    v_mul_f32 v31, v31, v10
    v_mul_f32 v8, v8, v10
    v_mul_f32 v9, v9, v10
    s_branch L_backx
L_rarem:
    v_mov_b32 v11, v10
    s_nop 1
    v_permlane16_swap_b32 v10, v11
    v_max_f32 v10, v10, v11
    v_mov_b32 v11, v10
    s_nop 1
    v_permlane32_swap_b32 v10, v11
    v_max3_f32 v6, v10, v11, v6
    v_mul_f32 v11, s68, v6
    v_and_b32 v11, s97, v11
    v_add_f32 v10, v7, v11
    v_exp_f32 v10, -v10
    v_sub_f32 v7, 0, v11
    v_mul_f32 v28, v28, v10
    v_mul_f32 v29, v29, v10
    v_mul_f32 v30, v30, v10
    v_mul_f32 v31, v31, v10
    v_mul_f32 v8, v8, v10
    v_mul_f32 v9, v9, v10
    s_branch L_backm
L_raref:
    v_mov_b32 v11, v10
    s_nop 1
    v_permlane16_swap_b32 v10, v11
    v_max_f32 v10, v10, v11
    v_mov_b32 v11, v10
    s_nop 1
    v_permlane32_swap_b32 v10, v11
    v_max3_f32 v6, v10, v11, v6
    v_mul_f32 v11, s68, v6
    v_and_b32 v11, s97, v11
    v_add_f32 v10, v7, v11
    v_exp_f32 v10, -v10
    v_sub_f32 v7, 0, v11
    v_mul_f32 v28, v28, v10
    v_mul_f32 v29, v29, v10
    v_mul_f32 v30, v30, v10
    v_mul_f32 v31, v31, v10
    v_mul_f32 v8, v8, v10
    v_mul_f32 v9, v9, v10
    s_branch L_backf
L_rareg:
    v_mov_b32 v11, v10
    s_nop 1
    v_permlane16_swap_b32 v10, v11
    v_max_f32 v10, v10, v11
    v_mov_b32 v11, v10
    s_nop 1
    v_permlane32_swap_b32 v10, v11
    v_max3_f32 v6, v10, v11, v6
    v_mul_f32 v11, s68, v6
    v_and_b32 v11, s97, v11
    v_add_f32 v10, v7, v11
    v_exp_f32 v10, -v10
    v_sub_f32 v7, 0, v11
    v_mul_f32 v28, v28, v10
    v_mul_f32 v29, v29, v10
    v_mul_f32 v30, v30, v10
    v_mul_f32 v31, v31, v10
    v_mul_f32 v8, v8, v10
    v_mul_f32 v9, v9, v10
    s_branch L_backg
L_rarel:
    v_mov_b32 v11, v10
    s_nop 1
    v_permlane16_swap_b32 v10, v11
    v_max_f32 v10, v10, v11
    v_mov_b32 v11, v10
    s_nop 1
    v_permlane32_swap_b32 v10, v11
    v_max3_f32 v6, v10, v11, v6
    v_mul_f32 v11, s68, v6
    v_and_b32 v11, s97, v11
    v_add_f32 v10, v7, v11
    v_exp_f32 v10, -v10
    v_sub_f32 v7, 0, v11
    v_mul_f32 v28, v28, v10
    v_mul_f32 v29, v29, v10
    v_mul_f32 v30, v30, v10
    v_mul_f32 v31, v31, v10
    v_mul_f32 v8, v8, v10
    v_mul_f32 v9, v9, v10
    s_branch L_backl
L_end:
    s_endpgm
.section .rodata,"a"
.p2align 6
.amdhsa_kernel parallel_sum__gqa_block_cached__glu_gated_glu__decode_kernel
  .amdhsa_next_free_vgpr 256
  .amdhsa_next_free_sgpr 102
  .amdhsa_accum_offset 256
  .amdhsa_group_segment_fixed_size 0
  .amdhsa_kernarg_size 96
  .amdhsa_user_sgpr_count 2
  .amdhsa_user_sgpr_kernarg_segment_ptr 1
  .amdhsa_system_sgpr_workgroup_id_x 1
  .amdhsa_float_denorm_mode_32 3
.end_amdhsa_kernel
```
